```python
import torch

def _softmax(x, axis=-1):
    return torch.softmax(x, dim=axis)
def _gelu(x):
    return torch.nn.functional.gelu(x, approximate="tanh")
def _silu(x):
    return torch.nn.functional.silu(x)
def _sigmoid(x):
    return torch.sigmoid(x)
def _layernorm(x, axis=-1, eps=1e-5):
    m = x.mean(dim=axis, keepdim=True)
    v = x.var(dim=axis, keepdim=True, unbiased=False)
    return (x - m) / torch.sqrt(v + eps)
def _scatter_add(tgt, idx, src, axis=0):
    return tgt.clone().index_add_(axis, idx, src)
def _segment_sum(src, seg, n):
    out = torch.zeros((n,) + src.shape[1:], dtype=src.dtype)
    return out.index_add_(0, seg, src)
def _pad(x, pw):
    flat = tuple(v for pair in reversed(pw) for v in pair)
    return torch.nn.functional.pad(x, flat)

kernel_name = 'standalone__normalfloat_lut_codebook_lookup__prompt'

def setup_inputs():

    _w = (lambda a: (lambda t: t.to(torch.bfloat16) if t.is_floating_point() else t)(torch.as_tensor(a)))
    B, S, D, F = 1, 2048, 1024, 3584
    G = -1 if -1 > 0 else D
    D = (D // G) * G
    ng = D // G
    nf4 = torch.tensor([
        -1.0, -0.6961928009986877, -0.5250730514526367, -0.39491748809814453,
        -0.28444138169288635, -0.18477343022823334, -0.09105003625154495, 0.0,
        0.07958029955625534, 0.16093020141124725, 0.24611230194568634, 0.33791524171829224,
        0.44070982933044434, 0.5626170039176941, 0.7229568362236023, 1.0
    ], dtype=float)
    qw = torch.randint(0, 16, (D, F)).to(torch.int64)
    absmax = (torch.abs((lambda *s: torch.randn(*s, dtype=torch.bfloat16) * 0.05)(ng, F)) + 0.01).to(float)
    return {
        "x": _w((lambda *s: torch.randn(*s, dtype=torch.bfloat16) * 0.05)(B, S, D)),
        "qw": _w(qw),
        "codebook": _w(nf4),
        "absmax": _w(absmax),
    }

def reference(x, qw, codebook, absmax):
    B, S, D = x.shape
    ng, F = absmax.shape
    G = D // ng
    w_nf = codebook[qw]
    s = (lambda x, n, axis: torch.repeat_interleave(x, n, dim=axis))(absmax, G, axis=0)
    w = (lambda x, dt: x.to(dt))(w_nf * s, x.dtype)
    return torch.einsum("bsd,df->bsf", x, w)
```

```asm
; @launch grid=(256,1,1) block=(512,1,1) lds=145920
.amdgcn_target "amdgcn-amd-amdhsa--gfx950"
.text
.globl standalone__normalfloat_lut_codebook_lookup__prompt_kernel
.p2align 8
.type standalone__normalfloat_lut_codebook_lookup__prompt_kernel,@function
standalone__normalfloat_lut_codebook_lookup__prompt_kernel:
    s_cmp_ge_u32 s2, 256
    s_cbranch_scc1 L_end
    s_load_dwordx2 s[28:29], s[0:1], 8
    s_load_dwordx8 s[4:11], s[0:1], 0
    s_load_dwordx4 s[12:15], s[0:1], 32
    s_load_dwordx2 s[34:35], s[0:1], 48
    v_readfirstlane_b32 s38, v0
    v_and_b32 v0, 63, v0
    s_lshr_b32 s41, s2, 3
    s_add_u32 s37, s41, s2
    s_and_b32 s37, s37, 7
    v_cmp_le_u32 vcc, 28, v0
    s_and_b32 s40, s2, 7
    s_lshr_b32 s39, s2, 6
    v_subrev_u32 v3, 28, v0
    s_lshl2_add_u32 s39, s40, s39
    s_lshr_b32 s38, s38, 6
    v_cndmask_b32 v3, v0, v3, vcc
    s_and_b32 s33, s39, 1
    s_lshl3_add_u32 s72, s37, s38
    s_xor_b32 s72, s72, 4
    v_lshl_add_u32 v3, s33, 2, v3
    s_mul_i32 s72, s72, 229376
    v_subrev_u32 v5, 28, v3
    s_mul_i32 s40, s39, 448
    v_min_u32 v3, v3, v5
    v_mov_b32 v2, 28672
    s_add_u32 s72, s72, s40
    v_cndmask_b32 v2, 0, v2, vcc
    s_mov_b32 s30, 14680064
    s_mov_b32 s31, 0x20000
    v_lshl_add_u32 v240, v3, 4, v2
    s_mov_b32 s50, -1
    s_mov_b32 s51, 0x00ffffff
    s_mov_b64 exec, s[50:51]
    s_waitcnt lgkmcnt(0)
    buffer_load_dwordx4 v[128:131], v240, s[28:31], s72 offen nt
    s_add_u32 s40, s72, 14336
    buffer_load_dwordx4 v[132:135], v240, s[28:31], s40 offen nt
    s_mov_b64 exec, -1
    s_mov_b32 s64, s8
    s_and_b32 s65, s9, 0xffff
    s_mov_b32 s66, 32
    s_mov_b32 s67, 0x20000
    s_mov_b32 s68, s10
    s_and_b32 s69, s11, 0xffff
    s_mov_b32 s70, 7168
    s_mov_b32 s71, 0x20000
    s_add_u32 s20, s34, 16777216
    s_addc_u32 s21, s35, 0
    s_and_b32 s21, s21, 0xffff
    s_mov_b32 s22, 7372800
    s_mov_b32 s23, 0x20000
    v_lshlrev_b32 v3, 3, v3
    v_lshlrev_b32 v4, 1, v0
    v_mov_b32 v5, 640
    s_mul_i32 s43, s39, 224
    s_lshl_b32 s75, s39, 10
    s_add_u32 s75, s75, 7340032
    buffer_load_ushort v6, v4, s[64:67], 0 offen
    buffer_load_dwordx2 v[14:15], v3, s[68:71], s43 offen
    buffer_load_dwordx2 v[242:243], v5, s[20:23], s75 offen sc1
    s_mov_b64 exec, s[50:51]
    s_add_u32 s40, s72, 114688
    buffer_load_dwordx4 v[136:139], v240, s[28:31], s40 offen nt
    s_add_u32 s40, s72, 129024
    buffer_load_dwordx4 v[140:143], v240, s[28:31], s40 offen nt
    s_add_u32 s40, s72, 57344
    buffer_load_dwordx4 v[144:147], v240, s[28:31], s40 offen nt
    s_add_u32 s40, s72, 71680
    buffer_load_dwordx4 v[148:151], v240, s[28:31], s40 offen nt
    s_add_u32 s40, s72, 172032
    buffer_load_dwordx4 v[152:155], v240, s[28:31], s40 offen nt
    s_add_u32 s40, s72, 186368
    buffer_load_dwordx4 v[156:159], v240, s[28:31], s40 offen nt
    s_mov_b64 exec, -1
    s_and_b32 s36, s41, 7
    s_lshl_b32 s36, s36, 8
    s_and_b32 s58, s38, 3
    s_lshr_b32 s57, s38, 2
    v_lshlrev_b32 v241, 4, v0
    v_lshlrev_b32 v248, 3, v0
    s_lshl1_add_u32 s74, s37, s57
    s_xor_b32 s74, s74, 1
    s_mul_i32 s45, s57, 47104
    s_mul_i32 s59, s39, 229376
    s_mul_i32 s49, s58, 3584
    s_cmp_eq_u32 s57, 1
    s_cbranch_scc1 L_P
    s_lshl_b32 s73, s38, 6
    s_add_u32 s73, s73, 141312
    s_mul_i32 s89, s74, 14336
    s_add_u32 s89, s89, s59
    s_add_u32 s89, s89, s49
    s_lshl_b32 s88, s74, 2
    s_add_u32 s88, s88, s58
    s_lshl_b32 s88, s88, 3
    s_add_u32 s88, s88, s75
    s_getreg_b32 s79, hwreg(HW_REG_XCC_ID, 0, 4)
    s_add_u32 s41, s45, s49
    s_add_u32 s41, s41, 32768
    v_add_u32 v249, s41, v241
    v_mov_b32 v16, 0
    v_mov_b32 v17, 0
    v_mov_b32 v18, 0
    v_mov_b32 v19, 0
    v_mov_b32 v20, 0
    v_mov_b32 v21, 0
    v_mov_b32 v22, 0
    v_mov_b32 v23, 0
    v_mov_b32 v24, 0
    v_mov_b32 v25, 0
    v_mov_b32 v26, 0
    v_mov_b32 v27, 0
    v_mov_b32 v28, 0
    v_mov_b32 v29, 0
    v_mov_b32 v30, 0
    v_mov_b32 v31, 0
    v_mov_b32 v32, 0
    v_mov_b32 v33, 0
    v_mov_b32 v34, 0
    v_mov_b32 v35, 0
    v_mov_b32 v36, 0
    v_mov_b32 v37, 0
    v_mov_b32 v38, 0
    v_mov_b32 v39, 0
    v_mov_b32 v40, 0
    v_mov_b32 v41, 0
    v_mov_b32 v42, 0
    v_mov_b32 v43, 0
    v_mov_b32 v44, 0
    v_mov_b32 v45, 0
    v_mov_b32 v46, 0
    v_mov_b32 v47, 0
    v_mov_b32 v48, 0
    v_mov_b32 v49, 0
    v_mov_b32 v50, 0
    v_mov_b32 v51, 0
    v_mov_b32 v52, 0
    v_mov_b32 v53, 0
    v_mov_b32 v54, 0
    v_mov_b32 v55, 0
    v_mov_b32 v56, 0
    v_mov_b32 v57, 0
    v_mov_b32 v58, 0
    v_mov_b32 v59, 0
    v_mov_b32 v60, 0
    v_mov_b32 v61, 0
    v_mov_b32 v62, 0
    v_mov_b32 v63, 0
    v_mov_b32 v64, 0
    v_mov_b32 v65, 0
    v_mov_b32 v66, 0
    v_mov_b32 v67, 0
    v_mov_b32 v68, 0
    v_mov_b32 v69, 0
    v_mov_b32 v70, 0
    v_mov_b32 v71, 0
    v_mov_b32 v72, 0
    v_mov_b32 v73, 0
    v_mov_b32 v74, 0
    v_mov_b32 v75, 0
    v_mov_b32 v76, 0
    v_mov_b32 v77, 0
    v_mov_b32 v78, 0
    v_mov_b32 v79, 0
    v_mov_b32 v80, 0
    v_mov_b32 v81, 0
    v_mov_b32 v82, 0
    v_mov_b32 v83, 0
    v_mov_b32 v84, 0
    v_mov_b32 v85, 0
    v_mov_b32 v86, 0
    v_mov_b32 v87, 0
    v_mov_b32 v88, 0
    v_mov_b32 v89, 0
    v_mov_b32 v90, 0
    v_mov_b32 v91, 0
    v_mov_b32 v92, 0
    v_mov_b32 v93, 0
    v_mov_b32 v94, 0
    v_mov_b32 v95, 0
    v_mov_b32 v96, 0
    v_mov_b32 v97, 0
    v_mov_b32 v98, 0
    v_mov_b32 v99, 0
    v_mov_b32 v100, 0
    v_mov_b32 v101, 0
    v_mov_b32 v102, 0
    v_mov_b32 v103, 0
    v_mov_b32 v104, 0
    v_mov_b32 v105, 0
    v_mov_b32 v106, 0
    v_mov_b32 v107, 0
    v_mov_b32 v108, 0
    v_mov_b32 v109, 0
    v_mov_b32 v110, 0
    v_mov_b32 v111, 0
    v_mov_b32 v112, 0
    v_mov_b32 v113, 0
    v_mov_b32 v114, 0
    v_mov_b32 v115, 0
    v_mov_b32 v116, 0
    v_mov_b32 v117, 0
    v_mov_b32 v118, 0
    v_mov_b32 v119, 0
    v_mov_b32 v120, 0
    v_mov_b32 v121, 0
    v_mov_b32 v122, 0
    v_mov_b32 v123, 0
    v_mov_b32 v124, 0
    v_mov_b32 v125, 0
    v_mov_b32 v126, 0
    v_mov_b32 v127, 0
    s_mov_b32 s24, s12
    s_and_b32 s25, s13, 0xffff
    s_mov_b32 s26, 14680064
    s_mov_b32 s27, 0x20000
    v_lshrrev_b32 v3, 4, v0
    v_and_b32 v4, 15, v0
    v_lshrrev_b32 v5, 1, v4
    v_xor_b32 v5, v5, v3
    v_lshlrev_b32 v5, 4, v5
    v_lshl_add_u32 v5, v4, 7, v5
    s_lshl_b32 s42, s38, 13
    v_add_u32 v1, s42, v5
    v_xor_b32 v2, 64, v1
    v_mov_b32 v8, v1
    v_mov_b32 v9, v2
    v_bfe_u32 v5, v0, 3, 2
    v_lshrrev_b32 v204, 5, v0
    v_lshl_add_u32 v5, v204, 3, v5
    v_mul_u32_u24 v5, 448, v5
    v_and_b32 v204, 3, v0
    v_lshl_add_u32 v5, v204, 4, v5
    v_bfe_u32 v204, v0, 2, 1
    v_lshl_add_u32 v5, v204, 3, v5
    v_add_u32 v7, 32768, v5
    v_mov_b32 v10, v7
    v_mov_b32 v11, v7
    s_mul_i32 s40, s38, 7680
    s_add_u32 s40, s40, 47104
    v_mul_u32_u24 v5, 240, v4
    v_lshl_add_u32 v5, v3, 3, v5
    v_add_u32 v12, s40, v5
    s_add_u32 s40, s42, 94208
    v_add_u32 v13, s40, v5
    v_mul_u32_u24 v5, 240, v3
    v_lshl_add_u32 v5, v4, 4, v5
    v_add_u32 v252, s40, v5
    s_lshl_b32 s42, s58, 6
    s_add_u32 s42, s42, s36
    s_add_u32 s42, s42, 32
    s_mul_i32 s42, s42, 7168
    s_add_u32 s42, s42, s43
    s_lshl_b32 s41, s33, 5
    s_add_u32 s41, s41, s42
    v_mul_u32_u24 v5, 7168, v3
    v_lshl_add_u32 v5, v4, 4, v5
    v_add_u32 v253, s41, v5
    s_cmp_eq_u32 s33, 1
    s_cselect_b32 s41, 0, 192
    s_add_u32 s42, s42, s41
    v_lshrrev_b32 v3, 1, v0
    v_and_b32 v4, 1, v0
    v_mul_u32_u24 v5, 7168, v3
    v_lshl_add_u32 v5, v4, 4, v5
    v_add_u32 v255, s42, v5
    v_mul_u32_u24 v5, 240, v3
    v_lshl_add_u32 v5, v4, 4, v5
    v_add_u32 v254, s40, v5
    s_mov_b32 s54, 0x0fff0fff
    s_mov_b32 s55, 0x0fff0fff
    s_mov_b64 exec, s[50:51]
    s_mov_b64 exec, -1
    s_waitcnt vmcnt(6)
    v_lshlrev_b32 v6, 16, v6
    v_lshl_add_u32 v205, v0, 2, s73
    s_mov_b64 exec, 0xffff
    ds_write_b32 v205, v6
    s_mov_b64 exec, -1
    v_lshlrev_b32 v244, 16, v14
    v_and_b32 v245, 0xffff0000, v14
    v_lshlrev_b32 v246, 16, v15
    v_and_b32 v247, 0xffff0000, v15
    s_mov_b32 s40, 1664525
    s_mov_b32 s41, 22695477
    v_mul_lo_u32 v242, v242, s40
    v_mul_lo_u32 v243, v243, s41
    v_add_u32 v242, 1013904223, v242
    v_add_u32 v243, 0x3c6ef35f, v243
    v_and_b32 v242, -16, v242
    v_or_b32 v242, s79, v242
    s_mov_b64 exec, s[50:51]
    v_lshl_add_u32 v128, v128, 2, s73
    ds_read_b32 v128, v128
    v_lshl_add_u32 v129, v129, 2, s73
    ds_read_b32 v129, v129
    v_lshl_add_u32 v130, v130, 2, s73
    ds_read_b32 v130, v130
    v_lshl_add_u32 v131, v131, 2, s73
    ds_read_b32 v131, v131
    v_lshl_add_u32 v132, v132, 2, s73
    ds_read_b32 v132, v132
    v_lshl_add_u32 v133, v133, 2, s73
    ds_read_b32 v133, v133
    v_lshl_add_u32 v134, v134, 2, s73
    ds_read_b32 v134, v134
    v_lshl_add_u32 v135, v135, 2, s73
    ds_read_b32 v135, v135
    s_waitcnt lgkmcnt(4)
    v_pk_mul_f32 v[128:129], v[128:129], v[244:245]
    v_pk_mul_f32 v[130:131], v[130:131], v[246:247]
    v_cvt_pk_bf16_f32 v160, v128, v129
    v_cvt_pk_bf16_f32 v161, v130, v131
    s_waitcnt lgkmcnt(0)
    v_pk_mul_f32 v[132:133], v[132:133], v[244:245]
    v_pk_mul_f32 v[134:135], v[134:135], v[246:247]
    v_cvt_pk_bf16_f32 v162, v132, v133
    v_cvt_pk_bf16_f32 v163, v134, v135
    buffer_store_dwordx4 v[160:163], v241, s[20:23], s89 offen offset:0
    ds_write_b128 v249, v[160:163] offset:0
    s_waitcnt vmcnt(5)
    v_lshl_add_u32 v136, v136, 2, s73
    ds_read_b32 v136, v136
    v_lshl_add_u32 v137, v137, 2, s73
    ds_read_b32 v137, v137
    v_lshl_add_u32 v138, v138, 2, s73
    ds_read_b32 v138, v138
    v_lshl_add_u32 v139, v139, 2, s73
    ds_read_b32 v139, v139
    v_lshl_add_u32 v140, v140, 2, s73
    ds_read_b32 v140, v140
    v_lshl_add_u32 v141, v141, 2, s73
    ds_read_b32 v141, v141
    v_lshl_add_u32 v142, v142, 2, s73
    ds_read_b32 v142, v142
    v_lshl_add_u32 v143, v143, 2, s73
    ds_read_b32 v143, v143
    s_waitcnt lgkmcnt(4)
    v_pk_mul_f32 v[136:137], v[136:137], v[244:245]
    v_pk_mul_f32 v[138:139], v[138:139], v[246:247]
    v_cvt_pk_bf16_f32 v164, v136, v137
    v_cvt_pk_bf16_f32 v165, v138, v139
    s_waitcnt lgkmcnt(0)
    v_pk_mul_f32 v[140:141], v[140:141], v[244:245]
    v_pk_mul_f32 v[142:143], v[142:143], v[246:247]
    v_cvt_pk_bf16_f32 v166, v140, v141
    v_cvt_pk_bf16_f32 v167, v142, v143
    buffer_store_dwordx4 v[164:167], v241, s[20:23], s89 offen offset:896
    ds_write_b128 v249, v[164:167] offset:896
    s_waitcnt vmcnt(4)
    v_lshl_add_u32 v144, v144, 2, s73
    ds_read_b32 v144, v144
    v_lshl_add_u32 v145, v145, 2, s73
    ds_read_b32 v145, v145
    v_lshl_add_u32 v146, v146, 2, s73
    ds_read_b32 v146, v146
    v_lshl_add_u32 v147, v147, 2, s73
    ds_read_b32 v147, v147
    v_lshl_add_u32 v148, v148, 2, s73
    ds_read_b32 v148, v148
    v_lshl_add_u32 v149, v149, 2, s73
    ds_read_b32 v149, v149
    v_lshl_add_u32 v150, v150, 2, s73
    ds_read_b32 v150, v150
    v_lshl_add_u32 v151, v151, 2, s73
    ds_read_b32 v151, v151
    s_waitcnt lgkmcnt(4)
    v_pk_mul_f32 v[144:145], v[144:145], v[244:245]
    v_pk_mul_f32 v[146:147], v[146:147], v[246:247]
    v_cvt_pk_bf16_f32 v168, v144, v145
    v_cvt_pk_bf16_f32 v169, v146, v147
    s_waitcnt lgkmcnt(0)
    v_pk_mul_f32 v[148:149], v[148:149], v[244:245]
    v_pk_mul_f32 v[150:151], v[150:151], v[246:247]
    v_cvt_pk_bf16_f32 v170, v148, v149
    v_cvt_pk_bf16_f32 v171, v150, v151
    buffer_store_dwordx4 v[168:171], v241, s[20:23], s89 offen offset:1792
    ds_write_b128 v249, v[168:171] offset:1792
    s_waitcnt vmcnt(3)
    v_lshl_add_u32 v152, v152, 2, s73
    ds_read_b32 v152, v152
    v_lshl_add_u32 v153, v153, 2, s73
    ds_read_b32 v153, v153
    v_lshl_add_u32 v154, v154, 2, s73
    ds_read_b32 v154, v154
    v_lshl_add_u32 v155, v155, 2, s73
    ds_read_b32 v155, v155
    v_lshl_add_u32 v156, v156, 2, s73
    ds_read_b32 v156, v156
    v_lshl_add_u32 v157, v157, 2, s73
    ds_read_b32 v157, v157
    v_lshl_add_u32 v158, v158, 2, s73
    ds_read_b32 v158, v158
    v_lshl_add_u32 v159, v159, 2, s73
    ds_read_b32 v159, v159
    s_waitcnt lgkmcnt(4)
    v_pk_mul_f32 v[152:153], v[152:153], v[244:245]
    v_pk_mul_f32 v[154:155], v[154:155], v[246:247]
    v_cvt_pk_bf16_f32 v172, v152, v153
    v_cvt_pk_bf16_f32 v173, v154, v155
    s_waitcnt lgkmcnt(0)
    v_pk_mul_f32 v[156:157], v[156:157], v[244:245]
    v_pk_mul_f32 v[158:159], v[158:159], v[246:247]
    v_cvt_pk_bf16_f32 v174, v156, v157
    v_cvt_pk_bf16_f32 v175, v158, v159
    buffer_store_dwordx4 v[172:175], v241, s[20:23], s89 offen offset:2688
    ds_write_b128 v249, v[172:175] offset:2688
    s_mov_b64 exec, -1
    s_waitcnt vmcnt(0)
    s_mov_b64 exec, 1
    buffer_store_dwordx2 v[242:243], v248, s[20:23], s88 offen
    s_mov_b64 exec, -1
    s_mov_b32 s44, 0
    s_waitcnt lgkmcnt(0)
    s_barrier
    ds_read_b64_tr_b16 v[192:193], v10 offset:0
    ds_read_b64_tr_b16 v[194:195], v10 offset:1792
    ds_read_b64_tr_b16 v[196:197], v10 offset:7168
    ds_read_b64_tr_b16 v[198:199], v10 offset:8960
    ds_read_b128 v[128:131], v8 offset:0
    ds_read_b128 v[132:135], v9 offset:0
    ds_read_b128 v[136:139], v8 offset:2048
    ds_read_b128 v[140:143], v9 offset:2048
    ds_read_b128 v[144:147], v8 offset:4096
    ds_read_b128 v[148:151], v9 offset:4096
    ds_read_b128 v[152:155], v8 offset:6144
    ds_read_b128 v[156:159], v9 offset:6144
    s_waitcnt lgkmcnt(0)
    ds_read_b64_tr_b16 v[200:201], v10 offset:64
    ds_read_b64_tr_b16 v[202:203], v10 offset:1856
    ds_read_b64_tr_b16 v[204:205], v10 offset:7232
    ds_read_b64_tr_b16 v[206:207], v10 offset:9024
    ds_read_b64_tr_b16 v[208:209], v10 offset:128
    ds_read_b64_tr_b16 v[210:211], v10 offset:1920
    ds_read_b64_tr_b16 v[212:213], v10 offset:7296
    ds_read_b64_tr_b16 v[214:215], v10 offset:9088
    ds_read_b64_tr_b16 v[216:217], v10 offset:192
    ds_read_b64_tr_b16 v[218:219], v10 offset:1984
    ds_read_b64_tr_b16 v[220:221], v10 offset:7360
    ds_read_b64_tr_b16 v[222:223], v10 offset:9152
L_cons_loop:
    v_mfma_f32_16x16x32_bf16 v[16:19], v[192:195], v[128:131], v[16:19]
    ds_read_b64_tr_b16 v[224:225], v10 offset:256
    v_mfma_f32_16x16x32_bf16 v[16:19], v[196:199], v[132:135], v[16:19]
    ds_read_b64_tr_b16 v[226:227], v10 offset:2048
    v_mfma_f32_16x16x32_bf16 v[44:47], v[196:199], v[140:143], v[44:47]
    ds_read_b64_tr_b16 v[228:229], v10 offset:7424
    v_mfma_f32_16x16x32_bf16 v[44:47], v[192:195], v[136:139], v[44:47]
    ds_read_b64_tr_b16 v[230:231], v10 offset:9216
    v_mfma_f32_16x16x32_bf16 v[72:75], v[192:195], v[144:147], v[72:75]
    v_mfma_f32_16x16x32_bf16 v[72:75], v[196:199], v[148:151], v[72:75]
    v_mfma_f32_16x16x32_bf16 v[100:103], v[196:199], v[156:159], v[100:103]
    s_waitcnt lgkmcnt(12)
    v_mfma_f32_16x16x32_bf16 v[100:103], v[192:195], v[152:155], v[100:103]
    v_mfma_f32_16x16x32_bf16 v[104:107], v[200:203], v[152:155], v[104:107]
    ds_read_b64_tr_b16 v[232:233], v10 offset:320
    v_mfma_f32_16x16x32_bf16 v[104:107], v[204:207], v[156:159], v[104:107]
    ds_read_b64_tr_b16 v[234:235], v10 offset:2112
    v_mfma_f32_16x16x32_bf16 v[76:79], v[204:207], v[148:151], v[76:79]
    ds_read_b64_tr_b16 v[236:237], v10 offset:7488
    v_mfma_f32_16x16x32_bf16 v[76:79], v[200:203], v[144:147], v[76:79]
    ds_read_b64_tr_b16 v[238:239], v10 offset:9280
    v_mfma_f32_16x16x32_bf16 v[48:51], v[200:203], v[136:139], v[48:51]
    v_mfma_f32_16x16x32_bf16 v[48:51], v[204:207], v[140:143], v[48:51]
    v_mfma_f32_16x16x32_bf16 v[20:23], v[204:207], v[132:135], v[20:23]
    s_waitcnt lgkmcnt(12)
    v_mfma_f32_16x16x32_bf16 v[20:23], v[200:203], v[128:131], v[20:23]
    v_mfma_f32_16x16x32_bf16 v[24:27], v[208:211], v[128:131], v[24:27]
    ds_read_b64_tr_b16 v[240:241], v10 offset:384
    v_mfma_f32_16x16x32_bf16 v[24:27], v[212:215], v[132:135], v[24:27]
    ds_read_b64_tr_b16 v[242:243], v10 offset:2176
    v_mfma_f32_16x16x32_bf16 v[52:55], v[212:215], v[140:143], v[52:55]
    ds_read_b64_tr_b16 v[244:245], v10 offset:7552
    v_mfma_f32_16x16x32_bf16 v[52:55], v[208:211], v[136:139], v[52:55]
    ds_read_b64_tr_b16 v[246:247], v10 offset:9344
    v_mfma_f32_16x16x32_bf16 v[80:83], v[208:211], v[144:147], v[80:83]
    v_mfma_f32_16x16x32_bf16 v[80:83], v[212:215], v[148:151], v[80:83]
    v_mfma_f32_16x16x32_bf16 v[108:111], v[212:215], v[156:159], v[108:111]
    s_waitcnt lgkmcnt(12)
    v_mfma_f32_16x16x32_bf16 v[108:111], v[208:211], v[152:155], v[108:111]
    v_mfma_f32_16x16x32_bf16 v[112:115], v[216:219], v[152:155], v[112:115]
    s_add_u32 s45, s45, 47104
    s_cmp_eq_u32 s45, 141312
    v_mfma_f32_16x16x32_bf16 v[112:115], v[220:223], v[156:159], v[112:115]
    s_cselect_b32 s45, 0, s45
    v_mfma_f32_16x16x32_bf16 v[84:87], v[220:223], v[148:151], v[84:87]
    v_add_u32 v8, s45, v1
    v_mfma_f32_16x16x32_bf16 v[84:87], v[216:219], v[144:147], v[84:87]
    v_add_u32 v9, s45, v2
    v_mfma_f32_16x16x32_bf16 v[56:59], v[216:219], v[136:139], v[56:59]
    v_add_u32 v10, s45, v7
    v_mfma_f32_16x16x32_bf16 v[56:59], v[220:223], v[140:143], v[56:59]
    s_add_u32 s44, s44, 1
    v_mfma_f32_16x16x32_bf16 v[28:31], v[220:223], v[132:135], v[28:31]
    s_waitcnt lgkmcnt(0)
    v_mfma_f32_16x16x32_bf16 v[28:31], v[216:219], v[128:131], v[28:31]
    s_barrier
    v_mfma_f32_16x16x32_bf16 v[32:35], v[224:227], v[128:131], v[32:35]
    ds_read_b64_tr_b16 v[192:193], v10 offset:0
    v_mfma_f32_16x16x32_bf16 v[32:35], v[228:231], v[132:135], v[32:35]
    ds_read_b64_tr_b16 v[194:195], v10 offset:1792
    v_mfma_f32_16x16x32_bf16 v[60:63], v[228:231], v[140:143], v[60:63]
    ds_read_b64_tr_b16 v[196:197], v10 offset:7168
    v_mfma_f32_16x16x32_bf16 v[60:63], v[224:227], v[136:139], v[60:63]
    ds_read_b64_tr_b16 v[198:199], v10 offset:8960
    v_mfma_f32_16x16x32_bf16 v[88:91], v[224:227], v[144:147], v[88:91]
    ds_read_b128 v[160:163], v8 offset:0
    v_mfma_f32_16x16x32_bf16 v[88:91], v[228:231], v[148:151], v[88:91]
    ds_read_b128 v[164:167], v9 offset:0
    v_mfma_f32_16x16x32_bf16 v[116:119], v[228:231], v[156:159], v[116:119]
    ds_read_b128 v[168:171], v8 offset:2048
    v_mfma_f32_16x16x32_bf16 v[116:119], v[224:227], v[152:155], v[116:119]
    ds_read_b128 v[172:175], v9 offset:2048
    v_mfma_f32_16x16x32_bf16 v[120:123], v[232:235], v[152:155], v[120:123]
    ds_read_b128 v[176:179], v8 offset:4096
    v_mfma_f32_16x16x32_bf16 v[120:123], v[236:239], v[156:159], v[120:123]
    ds_read_b128 v[180:183], v9 offset:4096
    v_mfma_f32_16x16x32_bf16 v[92:95], v[236:239], v[148:151], v[92:95]
    ds_read_b128 v[184:187], v8 offset:6144
    v_mfma_f32_16x16x32_bf16 v[92:95], v[232:235], v[144:147], v[92:95]
    ds_read_b128 v[188:191], v9 offset:6144
    v_mfma_f32_16x16x32_bf16 v[64:67], v[232:235], v[136:139], v[64:67]
    ds_read_b64_tr_b16 v[200:201], v10 offset:64
    ds_read_b64_tr_b16 v[202:203], v10 offset:1856
    v_mfma_f32_16x16x32_bf16 v[64:67], v[236:239], v[140:143], v[64:67]
    ds_read_b64_tr_b16 v[204:205], v10 offset:7232
    ds_read_b64_tr_b16 v[206:207], v10 offset:9024
    v_mfma_f32_16x16x32_bf16 v[36:39], v[236:239], v[132:135], v[36:39]
    ds_read_b64_tr_b16 v[208:209], v10 offset:128
    v_mfma_f32_16x16x32_bf16 v[36:39], v[232:235], v[128:131], v[36:39]
    ds_read_b64_tr_b16 v[210:211], v10 offset:1920
    v_mfma_f32_16x16x32_bf16 v[40:43], v[240:243], v[128:131], v[40:43]
    ds_read_b64_tr_b16 v[212:213], v10 offset:7296
    v_mfma_f32_16x16x32_bf16 v[40:43], v[244:247], v[132:135], v[40:43]
    ds_read_b64_tr_b16 v[214:215], v10 offset:9088
    v_mfma_f32_16x16x32_bf16 v[68:71], v[244:247], v[140:143], v[68:71]
    ds_read_b64_tr_b16 v[216:217], v10 offset:192
    v_mfma_f32_16x16x32_bf16 v[68:71], v[240:243], v[136:139], v[68:71]
    ds_read_b64_tr_b16 v[218:219], v10 offset:1984
    v_mfma_f32_16x16x32_bf16 v[96:99], v[240:243], v[144:147], v[96:99]
    ds_read_b64_tr_b16 v[220:221], v10 offset:7360
    v_mfma_f32_16x16x32_bf16 v[96:99], v[244:247], v[148:151], v[96:99]
    ds_read_b64_tr_b16 v[222:223], v10 offset:9152
    v_mfma_f32_16x16x32_bf16 v[124:127], v[244:247], v[156:159], v[124:127]
    s_waitcnt lgkmcnt(12)
    v_mfma_f32_16x16x32_bf16 v[124:127], v[240:243], v[152:155], v[124:127]
    v_mfma_f32_16x16x32_bf16 v[16:19], v[192:195], v[160:163], v[16:19]
    ds_read_b64_tr_b16 v[224:225], v10 offset:256
    v_mfma_f32_16x16x32_bf16 v[16:19], v[196:199], v[164:167], v[16:19]
    ds_read_b64_tr_b16 v[226:227], v10 offset:2048
    v_mfma_f32_16x16x32_bf16 v[44:47], v[196:199], v[172:175], v[44:47]
    ds_read_b64_tr_b16 v[228:229], v10 offset:7424
    v_mfma_f32_16x16x32_bf16 v[44:47], v[192:195], v[168:171], v[44:47]
    ds_read_b64_tr_b16 v[230:231], v10 offset:9216
    v_mfma_f32_16x16x32_bf16 v[72:75], v[192:195], v[176:179], v[72:75]
    v_mfma_f32_16x16x32_bf16 v[72:75], v[196:199], v[180:183], v[72:75]
    v_mfma_f32_16x16x32_bf16 v[100:103], v[196:199], v[188:191], v[100:103]
    s_waitcnt lgkmcnt(12)
    v_mfma_f32_16x16x32_bf16 v[100:103], v[192:195], v[184:187], v[100:103]
    v_mfma_f32_16x16x32_bf16 v[104:107], v[200:203], v[184:187], v[104:107]
    ds_read_b64_tr_b16 v[232:233], v10 offset:320
    v_mfma_f32_16x16x32_bf16 v[104:107], v[204:207], v[188:191], v[104:107]
    ds_read_b64_tr_b16 v[234:235], v10 offset:2112
    v_mfma_f32_16x16x32_bf16 v[76:79], v[204:207], v[180:183], v[76:79]
    ds_read_b64_tr_b16 v[236:237], v10 offset:7488
    v_mfma_f32_16x16x32_bf16 v[76:79], v[200:203], v[176:179], v[76:79]
    ds_read_b64_tr_b16 v[238:239], v10 offset:9280
    v_mfma_f32_16x16x32_bf16 v[48:51], v[200:203], v[168:171], v[48:51]
    v_mfma_f32_16x16x32_bf16 v[48:51], v[204:207], v[172:175], v[48:51]
    v_mfma_f32_16x16x32_bf16 v[20:23], v[204:207], v[164:167], v[20:23]
    s_waitcnt lgkmcnt(12)
    v_mfma_f32_16x16x32_bf16 v[20:23], v[200:203], v[160:163], v[20:23]
    v_mfma_f32_16x16x32_bf16 v[24:27], v[208:211], v[160:163], v[24:27]
    ds_read_b64_tr_b16 v[240:241], v10 offset:384
    v_mfma_f32_16x16x32_bf16 v[24:27], v[212:215], v[164:167], v[24:27]
    ds_read_b64_tr_b16 v[242:243], v10 offset:2176
    v_mfma_f32_16x16x32_bf16 v[52:55], v[212:215], v[172:175], v[52:55]
    ds_read_b64_tr_b16 v[244:245], v10 offset:7552
    v_mfma_f32_16x16x32_bf16 v[52:55], v[208:211], v[168:171], v[52:55]
    ds_read_b64_tr_b16 v[246:247], v10 offset:9344
    v_mfma_f32_16x16x32_bf16 v[80:83], v[208:211], v[176:179], v[80:83]
    v_mfma_f32_16x16x32_bf16 v[80:83], v[212:215], v[180:183], v[80:83]
    v_mfma_f32_16x16x32_bf16 v[108:111], v[212:215], v[188:191], v[108:111]
    s_waitcnt lgkmcnt(12)
    v_mfma_f32_16x16x32_bf16 v[108:111], v[208:211], v[184:187], v[108:111]
    v_mfma_f32_16x16x32_bf16 v[112:115], v[216:219], v[184:187], v[112:115]
    s_add_u32 s45, s45, 47104
    s_cmp_eq_u32 s45, 141312
    v_mfma_f32_16x16x32_bf16 v[112:115], v[220:223], v[188:191], v[112:115]
    s_cselect_b32 s45, 0, s45
    v_mfma_f32_16x16x32_bf16 v[84:87], v[220:223], v[180:183], v[84:87]
    v_add_u32 v8, s45, v1
    v_mfma_f32_16x16x32_bf16 v[84:87], v[216:219], v[176:179], v[84:87]
    v_add_u32 v9, s45, v2
    v_mfma_f32_16x16x32_bf16 v[56:59], v[216:219], v[168:171], v[56:59]
    v_add_u32 v10, s45, v7
    v_mfma_f32_16x16x32_bf16 v[56:59], v[220:223], v[172:175], v[56:59]
    s_add_u32 s44, s44, 1
    v_mfma_f32_16x16x32_bf16 v[28:31], v[220:223], v[164:167], v[28:31]
    s_waitcnt lgkmcnt(0)
    v_mfma_f32_16x16x32_bf16 v[28:31], v[216:219], v[160:163], v[28:31]
    s_barrier
    v_mfma_f32_16x16x32_bf16 v[32:35], v[224:227], v[160:163], v[32:35]
    ds_read_b64_tr_b16 v[192:193], v10 offset:0
    v_mfma_f32_16x16x32_bf16 v[32:35], v[228:231], v[164:167], v[32:35]
    ds_read_b64_tr_b16 v[194:195], v10 offset:1792
    v_mfma_f32_16x16x32_bf16 v[60:63], v[228:231], v[172:175], v[60:63]
    ds_read_b64_tr_b16 v[196:197], v10 offset:7168
    v_mfma_f32_16x16x32_bf16 v[60:63], v[224:227], v[168:171], v[60:63]
    ds_read_b64_tr_b16 v[198:199], v10 offset:8960
    v_mfma_f32_16x16x32_bf16 v[88:91], v[224:227], v[176:179], v[88:91]
    ds_read_b128 v[128:131], v8 offset:0
    v_mfma_f32_16x16x32_bf16 v[88:91], v[228:231], v[180:183], v[88:91]
    ds_read_b128 v[132:135], v9 offset:0
    v_mfma_f32_16x16x32_bf16 v[116:119], v[228:231], v[188:191], v[116:119]
    ds_read_b128 v[136:139], v8 offset:2048
    v_mfma_f32_16x16x32_bf16 v[116:119], v[224:227], v[184:187], v[116:119]
    ds_read_b128 v[140:143], v9 offset:2048
    v_mfma_f32_16x16x32_bf16 v[120:123], v[232:235], v[184:187], v[120:123]
    ds_read_b128 v[144:147], v8 offset:4096
    v_mfma_f32_16x16x32_bf16 v[120:123], v[236:239], v[188:191], v[120:123]
    ds_read_b128 v[148:151], v9 offset:4096
    v_mfma_f32_16x16x32_bf16 v[92:95], v[236:239], v[180:183], v[92:95]
    ds_read_b128 v[152:155], v8 offset:6144
    v_mfma_f32_16x16x32_bf16 v[92:95], v[232:235], v[176:179], v[92:95]
    ds_read_b128 v[156:159], v9 offset:6144
    v_mfma_f32_16x16x32_bf16 v[64:67], v[232:235], v[168:171], v[64:67]
    ds_read_b64_tr_b16 v[200:201], v10 offset:64
    ds_read_b64_tr_b16 v[202:203], v10 offset:1856
    v_mfma_f32_16x16x32_bf16 v[64:67], v[236:239], v[172:175], v[64:67]
    ds_read_b64_tr_b16 v[204:205], v10 offset:7232
    ds_read_b64_tr_b16 v[206:207], v10 offset:9024
    v_mfma_f32_16x16x32_bf16 v[36:39], v[236:239], v[164:167], v[36:39]
    ds_read_b64_tr_b16 v[208:209], v10 offset:128
    v_mfma_f32_16x16x32_bf16 v[36:39], v[232:235], v[160:163], v[36:39]
    ds_read_b64_tr_b16 v[210:211], v10 offset:1920
    v_mfma_f32_16x16x32_bf16 v[40:43], v[240:243], v[160:163], v[40:43]
    ds_read_b64_tr_b16 v[212:213], v10 offset:7296
    v_mfma_f32_16x16x32_bf16 v[40:43], v[244:247], v[164:167], v[40:43]
    ds_read_b64_tr_b16 v[214:215], v10 offset:9088
    v_mfma_f32_16x16x32_bf16 v[68:71], v[244:247], v[172:175], v[68:71]
    ds_read_b64_tr_b16 v[216:217], v10 offset:192
    v_mfma_f32_16x16x32_bf16 v[68:71], v[240:243], v[168:171], v[68:71]
    ds_read_b64_tr_b16 v[218:219], v10 offset:1984
    v_mfma_f32_16x16x32_bf16 v[96:99], v[240:243], v[176:179], v[96:99]
    ds_read_b64_tr_b16 v[220:221], v10 offset:7360
    v_mfma_f32_16x16x32_bf16 v[96:99], v[244:247], v[180:183], v[96:99]
    ds_read_b64_tr_b16 v[222:223], v10 offset:9152
    v_mfma_f32_16x16x32_bf16 v[124:127], v[244:247], v[188:191], v[124:127]
    s_waitcnt lgkmcnt(12)
    s_cmp_lt_u32 s44, 14
    v_mfma_f32_16x16x32_bf16 v[124:127], v[240:243], v[184:187], v[124:127]
    s_cbranch_scc1 L_cons_loop
L_cons_tail:
    v_mov_b32 v11, v10
    v_mfma_f32_16x16x32_bf16 v[16:19], v[192:195], v[128:131], v[16:19]
    s_add_u32 s45, s45, 47104
    s_cmp_eq_u32 s45, 141312
    v_mfma_f32_16x16x32_bf16 v[16:19], v[196:199], v[132:135], v[16:19]
    s_cselect_b32 s45, 0, s45
    v_add_u32 v8, s45, v1
    v_mfma_f32_16x16x32_bf16 v[44:47], v[196:199], v[140:143], v[44:47]
    v_add_u32 v9, s45, v2
    v_add_u32 v10, s45, v7
    v_mfma_f32_16x16x32_bf16 v[44:47], v[192:195], v[136:139], v[44:47]
    ds_read_b64_tr_b16 v[224:225], v11 offset:256
    ds_read_b64_tr_b16 v[226:227], v11 offset:2048
    v_mfma_f32_16x16x32_bf16 v[72:75], v[192:195], v[144:147], v[72:75]
    ds_read_b64_tr_b16 v[228:229], v11 offset:7424
    v_mfma_f32_16x16x32_bf16 v[72:75], v[196:199], v[148:151], v[72:75]
    ds_read_b64_tr_b16 v[230:231], v11 offset:9216
    v_mfma_f32_16x16x32_bf16 v[100:103], v[196:199], v[156:159], v[100:103]
    ds_read_b64_tr_b16 v[232:233], v11 offset:320
    v_mfma_f32_16x16x32_bf16 v[100:103], v[192:195], v[152:155], v[100:103]
    ds_read_b64_tr_b16 v[234:235], v11 offset:2112
    s_waitcnt lgkmcnt(14)
    v_mfma_f32_16x16x32_bf16 v[48:51], v[200:203], v[136:139], v[48:51]
    ds_read_b64_tr_b16 v[236:237], v11 offset:7488
    ds_read_b64_tr_b16 v[238:239], v11 offset:9280
    v_mfma_f32_16x16x32_bf16 v[48:51], v[204:207], v[140:143], v[48:51]
    ds_read_b64_tr_b16 v[240:241], v11 offset:384
    ds_read_b64_tr_b16 v[242:243], v11 offset:2176
    v_mfma_f32_16x16x32_bf16 v[20:23], v[204:207], v[132:135], v[20:23]
    ds_read_b64_tr_b16 v[244:245], v11 offset:7552
    v_mfma_f32_16x16x32_bf16 v[20:23], v[200:203], v[128:131], v[20:23]
    ds_read_b64_tr_b16 v[246:247], v11 offset:9344
    s_waitcnt lgkmcnt(15)
    v_mfma_f32_16x16x32_bf16 v[24:27], v[208:211], v[128:131], v[24:27]
    v_mfma_f32_16x16x32_bf16 v[24:27], v[212:215], v[132:135], v[24:27]
    v_mfma_f32_16x16x32_bf16 v[52:55], v[212:215], v[140:143], v[52:55]
    v_mfma_f32_16x16x32_bf16 v[52:55], v[208:211], v[136:139], v[52:55]
    s_barrier
    s_waitcnt lgkmcnt(12)
    v_mfma_f32_16x16x32_bf16 v[56:59], v[216:219], v[136:139], v[56:59]
    ds_read_b128 v[160:163], v8 offset:0
    ds_read_b128 v[164:167], v9 offset:0
    v_mfma_f32_16x16x32_bf16 v[56:59], v[220:223], v[140:143], v[56:59]
    ds_read_b128 v[168:171], v8 offset:2048
    ds_read_b128 v[172:175], v9 offset:2048
    v_mfma_f32_16x16x32_bf16 v[28:31], v[220:223], v[132:135], v[28:31]
    ds_read_b64_tr_b16 v[192:193], v10 offset:0
    v_mfma_f32_16x16x32_bf16 v[28:31], v[216:219], v[128:131], v[28:31]
    ds_read_b64_tr_b16 v[194:195], v10 offset:1792
    s_waitcnt lgkmcnt(14)
    v_mfma_f32_16x16x32_bf16 v[32:35], v[224:227], v[128:131], v[32:35]
    ds_read_b64_tr_b16 v[196:197], v10 offset:7168
    ds_read_b64_tr_b16 v[198:199], v10 offset:8960
    v_mfma_f32_16x16x32_bf16 v[32:35], v[228:231], v[132:135], v[32:35]
    ds_read_b64_tr_b16 v[200:201], v10 offset:64
    ds_read_b64_tr_b16 v[202:203], v10 offset:1856
    v_mfma_f32_16x16x32_bf16 v[60:63], v[228:231], v[140:143], v[60:63]
    ds_read_b64_tr_b16 v[204:205], v10 offset:7232
    v_mfma_f32_16x16x32_bf16 v[60:63], v[224:227], v[136:139], v[60:63]
    ds_read_b64_tr_b16 v[206:207], v10 offset:9024
    s_waitcnt lgkmcnt(15)
    v_mfma_f32_16x16x32_bf16 v[64:67], v[232:235], v[136:139], v[64:67]
    ds_read_b64_tr_b16 v[208:209], v10 offset:128
    ds_read_b64_tr_b16 v[210:211], v10 offset:1920
    v_mfma_f32_16x16x32_bf16 v[64:67], v[236:239], v[140:143], v[64:67]
    ds_read_b64_tr_b16 v[212:213], v10 offset:7296
    ds_read_b64_tr_b16 v[214:215], v10 offset:9088
    v_mfma_f32_16x16x32_bf16 v[36:39], v[236:239], v[132:135], v[36:39]
    ds_read_b64_tr_b16 v[216:217], v10 offset:192
    v_mfma_f32_16x16x32_bf16 v[36:39], v[232:235], v[128:131], v[36:39]
    ds_read_b64_tr_b16 v[218:219], v10 offset:1984
    s_waitcnt lgkmcnt(15)
    v_mfma_f32_16x16x32_bf16 v[40:43], v[240:243], v[128:131], v[40:43]
    ds_read_b64_tr_b16 v[220:221], v10 offset:7360
    ds_read_b64_tr_b16 v[222:223], v10 offset:9152
    v_mfma_f32_16x16x32_bf16 v[40:43], v[244:247], v[132:135], v[40:43]
    ds_read_b64_tr_b16 v[224:225], v10 offset:256
    ds_read_b64_tr_b16 v[226:227], v10 offset:2048
    v_mfma_f32_16x16x32_bf16 v[68:71], v[244:247], v[140:143], v[68:71]
    ds_read_b64_tr_b16 v[228:229], v10 offset:7424
    v_mfma_f32_16x16x32_bf16 v[68:71], v[240:243], v[136:139], v[68:71]
    ds_read_b64_tr_b16 v[230:231], v10 offset:9216
    s_waitcnt lgkmcnt(15)
    v_mfma_f32_16x16x32_bf16 v[16:19], v[192:195], v[160:163], v[16:19]
    ds_read_b64_tr_b16 v[232:233], v10 offset:320
    ds_read_b64_tr_b16 v[234:235], v10 offset:2112
    v_mfma_f32_16x16x32_bf16 v[16:19], v[196:199], v[164:167], v[16:19]
    ds_read_b64_tr_b16 v[236:237], v10 offset:7488
    ds_read_b64_tr_b16 v[238:239], v10 offset:9280
    v_mfma_f32_16x16x32_bf16 v[44:47], v[196:199], v[172:175], v[44:47]
    ds_read_b64_tr_b16 v[240:241], v10 offset:384
    v_mfma_f32_16x16x32_bf16 v[44:47], v[192:195], v[168:171], v[44:47]
    ds_read_b64_tr_b16 v[242:243], v10 offset:2176
    s_waitcnt lgkmcnt(15)
    v_mfma_f32_16x16x32_bf16 v[48:51], v[200:203], v[168:171], v[48:51]
    ds_read_b64_tr_b16 v[244:245], v10 offset:7552
    ds_read_b64_tr_b16 v[246:247], v10 offset:9344
    v_mfma_f32_16x16x32_bf16 v[48:51], v[204:207], v[172:175], v[48:51]
    ds_read_b128 v[176:179], v8 offset:4096
    ds_read_b128 v[180:183], v9 offset:4096
    v_mfma_f32_16x16x32_bf16 v[20:23], v[204:207], v[164:167], v[20:23]
    ds_read_b128 v[184:187], v8 offset:6144
    v_mfma_f32_16x16x32_bf16 v[20:23], v[200:203], v[160:163], v[20:23]
    ds_read_b128 v[188:191], v9 offset:6144
    s_waitcnt lgkmcnt(15)
    v_mfma_f32_16x16x32_bf16 v[24:27], v[208:211], v[160:163], v[24:27]
    v_cvt_pk_bf16_f32 v16, v16, v17
    v_cvt_pk_bf16_f32 v17, v18, v19
    v_mfma_f32_16x16x32_bf16 v[24:27], v[212:215], v[164:167], v[24:27]
    ds_write_b64 v12, v[16:17] offset:0
    v_cvt_pk_bf16_f32 v44, v44, v45
    v_mfma_f32_16x16x32_bf16 v[52:55], v[212:215], v[172:175], v[52:55]
    v_cvt_pk_bf16_f32 v45, v46, v47
    v_mfma_f32_16x16x32_bf16 v[52:55], v[208:211], v[168:171], v[52:55]
    ds_write_b64 v12, v[44:45] offset:3840
    s_waitcnt lgkmcnt(15)
    v_mfma_f32_16x16x32_bf16 v[56:59], v[216:219], v[168:171], v[56:59]
    v_cvt_pk_bf16_f32 v48, v48, v49
    v_cvt_pk_bf16_f32 v49, v50, v51
    v_mfma_f32_16x16x32_bf16 v[56:59], v[220:223], v[172:175], v[56:59]
    ds_write_b64 v12, v[48:49] offset:3872
    v_cvt_pk_bf16_f32 v20, v20, v21
    v_mfma_f32_16x16x32_bf16 v[28:31], v[220:223], v[164:167], v[28:31]
    v_cvt_pk_bf16_f32 v21, v22, v23
    v_mfma_f32_16x16x32_bf16 v[28:31], v[216:219], v[160:163], v[28:31]
    ds_write_b64 v12, v[20:21] offset:32
    s_waitcnt lgkmcnt(15)
    v_mfma_f32_16x16x32_bf16 v[32:35], v[224:227], v[160:163], v[32:35]
    v_cvt_pk_bf16_f32 v24, v24, v25
    v_cvt_pk_bf16_f32 v25, v26, v27
    v_mfma_f32_16x16x32_bf16 v[32:35], v[228:231], v[164:167], v[32:35]
    ds_write_b64 v12, v[24:25] offset:64
    v_cvt_pk_bf16_f32 v52, v52, v53
    v_mfma_f32_16x16x32_bf16 v[60:63], v[228:231], v[172:175], v[60:63]
    v_cvt_pk_bf16_f32 v53, v54, v55
    v_mfma_f32_16x16x32_bf16 v[60:63], v[224:227], v[168:171], v[60:63]
    ds_write_b64 v12, v[52:53] offset:3904
    s_waitcnt lgkmcnt(14)
    v_mfma_f32_16x16x32_bf16 v[64:67], v[232:235], v[168:171], v[64:67]
    v_cvt_pk_bf16_f32 v56, v56, v57
    v_cvt_pk_bf16_f32 v57, v58, v59
    v_mfma_f32_16x16x32_bf16 v[64:67], v[236:239], v[172:175], v[64:67]
    ds_write_b64 v12, v[56:57] offset:3936
    v_cvt_pk_bf16_f32 v28, v28, v29
    v_mfma_f32_16x16x32_bf16 v[36:39], v[236:239], v[164:167], v[36:39]
    v_cvt_pk_bf16_f32 v29, v30, v31
    v_mfma_f32_16x16x32_bf16 v[36:39], v[232:235], v[160:163], v[36:39]
    ds_write_b64 v12, v[28:29] offset:96
    s_waitcnt lgkmcnt(12)
    v_mfma_f32_16x16x32_bf16 v[40:43], v[240:243], v[160:163], v[40:43]
    v_cvt_pk_bf16_f32 v32, v32, v33
    v_cvt_pk_bf16_f32 v33, v34, v35
    v_mfma_f32_16x16x32_bf16 v[40:43], v[244:247], v[164:167], v[40:43]
    ds_write_b64 v12, v[32:33] offset:128
    v_cvt_pk_bf16_f32 v60, v60, v61
    v_mfma_f32_16x16x32_bf16 v[68:71], v[244:247], v[172:175], v[68:71]
    v_cvt_pk_bf16_f32 v61, v62, v63
    v_mfma_f32_16x16x32_bf16 v[68:71], v[240:243], v[168:171], v[68:71]
    ds_write_b64 v12, v[60:61] offset:3968
    s_waitcnt lgkmcnt(10)
    v_mfma_f32_16x16x32_bf16 v[104:107], v[200:203], v[184:187], v[104:107]
    v_cvt_pk_bf16_f32 v64, v64, v65
    v_cvt_pk_bf16_f32 v65, v66, v67
    v_mfma_f32_16x16x32_bf16 v[104:107], v[204:207], v[188:191], v[104:107]
    ds_write_b64 v12, v[64:65] offset:4000
    v_cvt_pk_bf16_f32 v36, v36, v37
    v_mfma_f32_16x16x32_bf16 v[76:79], v[204:207], v[180:183], v[76:79]
    v_cvt_pk_bf16_f32 v37, v38, v39
    v_mfma_f32_16x16x32_bf16 v[76:79], v[200:203], v[176:179], v[76:79]
    ds_write_b64 v12, v[36:37] offset:160
    v_mfma_f32_16x16x32_bf16 v[80:83], v[208:211], v[176:179], v[80:83]
    v_cvt_pk_bf16_f32 v40, v40, v41
    v_cvt_pk_bf16_f32 v41, v42, v43
    v_mfma_f32_16x16x32_bf16 v[80:83], v[212:215], v[180:183], v[80:83]
    ds_write_b64 v12, v[40:41] offset:192
    v_cvt_pk_bf16_f32 v68, v68, v69
    v_mfma_f32_16x16x32_bf16 v[108:111], v[212:215], v[188:191], v[108:111]
    v_cvt_pk_bf16_f32 v69, v70, v71
    v_mfma_f32_16x16x32_bf16 v[108:111], v[208:211], v[184:187], v[108:111]
    ds_write_b64 v12, v[68:69] offset:4032
    v_mfma_f32_16x16x32_bf16 v[112:115], v[216:219], v[184:187], v[112:115]
    s_nop 0
    s_nop 0
    v_mfma_f32_16x16x32_bf16 v[112:115], v[220:223], v[188:191], v[112:115]
    s_nop 0
    s_waitcnt lgkmcnt(0)
    v_mfma_f32_16x16x32_bf16 v[84:87], v[220:223], v[180:183], v[84:87]
    s_barrier
    v_mfma_f32_16x16x32_bf16 v[84:87], v[216:219], v[176:179], v[84:87]
    ds_read_b64_tr_b16 v[200:201], v11 offset:64
    v_mfma_f32_16x16x32_bf16 v[88:91], v[224:227], v[176:179], v[88:91]
    ds_read_b64_tr_b16 v[202:203], v11 offset:1856
    ds_read_b64_tr_b16 v[204:205], v11 offset:7232
    v_mfma_f32_16x16x32_bf16 v[88:91], v[228:231], v[180:183], v[88:91]
    ds_read_b64_tr_b16 v[206:207], v11 offset:9024
    ds_read_b64_tr_b16 v[208:209], v11 offset:128
    v_mfma_f32_16x16x32_bf16 v[116:119], v[228:231], v[188:191], v[116:119]
    ds_read_b64_tr_b16 v[210:211], v11 offset:1920
    v_mfma_f32_16x16x32_bf16 v[116:119], v[224:227], v[184:187], v[116:119]
    ds_read_b64_tr_b16 v[212:213], v11 offset:7296
    v_mfma_f32_16x16x32_bf16 v[120:123], v[232:235], v[184:187], v[120:123]
    ds_read_b64_tr_b16 v[214:215], v11 offset:9088
    ds_read_b64_tr_b16 v[216:217], v11 offset:192
    v_mfma_f32_16x16x32_bf16 v[120:123], v[236:239], v[188:191], v[120:123]
    ds_read_b64_tr_b16 v[218:219], v11 offset:1984
    ds_read_b64_tr_b16 v[220:221], v11 offset:7360
    v_mfma_f32_16x16x32_bf16 v[92:95], v[236:239], v[180:183], v[92:95]
    ds_read_b64_tr_b16 v[222:223], v11 offset:9152
    v_mfma_f32_16x16x32_bf16 v[92:95], v[232:235], v[176:179], v[92:95]
    ds_read_b64_tr_b16 v[224:225], v11 offset:256
    v_mfma_f32_16x16x32_bf16 v[96:99], v[240:243], v[176:179], v[96:99]
    ds_read_b64_tr_b16 v[226:227], v11 offset:2048
    ds_read_b64_tr_b16 v[228:229], v11 offset:7424
    v_mfma_f32_16x16x32_bf16 v[96:99], v[244:247], v[180:183], v[96:99]
    ds_read_b64_tr_b16 v[230:231], v11 offset:9216
    ds_read_b64_tr_b16 v[232:233], v11 offset:320
    v_mfma_f32_16x16x32_bf16 v[124:127], v[244:247], v[188:191], v[124:127]
    ds_read_b64_tr_b16 v[234:235], v11 offset:2112
    v_mfma_f32_16x16x32_bf16 v[124:127], v[240:243], v[184:187], v[124:127]
    ds_read_b64_tr_b16 v[236:237], v11 offset:7488
    v_mfma_f32_16x16x32_bf16 v[72:75], v[192:195], v[176:179], v[72:75]
    ds_read_b64_tr_b16 v[238:239], v11 offset:9280
    ds_read_b64_tr_b16 v[240:241], v11 offset:384
    v_mfma_f32_16x16x32_bf16 v[72:75], v[196:199], v[180:183], v[72:75]
    ds_read_b64_tr_b16 v[242:243], v11 offset:2176
    v_mfma_f32_16x16x32_bf16 v[100:103], v[196:199], v[188:191], v[100:103]
    ds_read_b64_tr_b16 v[244:245], v11 offset:7552
    v_mfma_f32_16x16x32_bf16 v[100:103], v[192:195], v[184:187], v[100:103]
    ds_read_b64_tr_b16 v[246:247], v11 offset:9344
    s_waitcnt lgkmcnt(15)
    v_mfma_f32_16x16x32_bf16 v[104:107], v[200:203], v[152:155], v[104:107]
    v_mfma_f32_16x16x32_bf16 v[104:107], v[204:207], v[156:159], v[104:107]
    v_mfma_f32_16x16x32_bf16 v[76:79], v[204:207], v[148:151], v[76:79]
    v_mfma_f32_16x16x32_bf16 v[76:79], v[200:203], v[144:147], v[76:79]
    s_waitcnt lgkmcnt(15)
    v_mfma_f32_16x16x32_bf16 v[80:83], v[208:211], v[144:147], v[80:83]
    v_cvt_pk_bf16_f32 v72, v72, v73
    v_cvt_pk_bf16_f32 v73, v74, v75
    v_mfma_f32_16x16x32_bf16 v[80:83], v[212:215], v[148:151], v[80:83]
    ds_write_b64 v13, v[72:73] offset:0
    v_cvt_pk_bf16_f32 v100, v100, v101
    v_mfma_f32_16x16x32_bf16 v[108:111], v[212:215], v[156:159], v[108:111]
    v_cvt_pk_bf16_f32 v101, v102, v103
    v_mfma_f32_16x16x32_bf16 v[108:111], v[208:211], v[152:155], v[108:111]
    ds_write_b64 v13, v[100:101] offset:3840
    s_waitcnt lgkmcnt(14)
    v_mfma_f32_16x16x32_bf16 v[112:115], v[216:219], v[152:155], v[112:115]
    v_cvt_pk_bf16_f32 v104, v104, v105
    v_cvt_pk_bf16_f32 v105, v106, v107
    v_mfma_f32_16x16x32_bf16 v[112:115], v[220:223], v[156:159], v[112:115]
    ds_write_b64 v13, v[104:105] offset:3872
    v_cvt_pk_bf16_f32 v76, v76, v77
    v_mfma_f32_16x16x32_bf16 v[84:87], v[220:223], v[148:151], v[84:87]
    v_cvt_pk_bf16_f32 v77, v78, v79
    v_mfma_f32_16x16x32_bf16 v[84:87], v[216:219], v[144:147], v[84:87]
    ds_write_b64 v13, v[76:77] offset:32
    s_waitcnt lgkmcnt(12)
    v_mfma_f32_16x16x32_bf16 v[88:91], v[224:227], v[144:147], v[88:91]
    v_cvt_pk_bf16_f32 v80, v80, v81
    v_cvt_pk_bf16_f32 v81, v82, v83
    v_mfma_f32_16x16x32_bf16 v[88:91], v[228:231], v[148:151], v[88:91]
    ds_write_b64 v13, v[80:81] offset:64
    v_cvt_pk_bf16_f32 v108, v108, v109
    v_mfma_f32_16x16x32_bf16 v[116:119], v[228:231], v[156:159], v[116:119]
    v_cvt_pk_bf16_f32 v109, v110, v111
    v_mfma_f32_16x16x32_bf16 v[116:119], v[224:227], v[152:155], v[116:119]
    ds_write_b64 v13, v[108:109] offset:3904
    s_waitcnt lgkmcnt(10)
    v_mfma_f32_16x16x32_bf16 v[120:123], v[232:235], v[152:155], v[120:123]
    v_cvt_pk_bf16_f32 v112, v112, v113
    v_cvt_pk_bf16_f32 v113, v114, v115
    v_mfma_f32_16x16x32_bf16 v[120:123], v[236:239], v[156:159], v[120:123]
    ds_write_b64 v13, v[112:113] offset:3936
    v_cvt_pk_bf16_f32 v84, v84, v85
    v_mfma_f32_16x16x32_bf16 v[92:95], v[236:239], v[148:151], v[92:95]
    v_cvt_pk_bf16_f32 v85, v86, v87
    v_mfma_f32_16x16x32_bf16 v[92:95], v[232:235], v[144:147], v[92:95]
    ds_write_b64 v13, v[84:85] offset:96
    s_waitcnt lgkmcnt(8)
    v_mfma_f32_16x16x32_bf16 v[96:99], v[240:243], v[144:147], v[96:99]
    v_cvt_pk_bf16_f32 v88, v88, v89
    v_cvt_pk_bf16_f32 v89, v90, v91
    v_mfma_f32_16x16x32_bf16 v[96:99], v[244:247], v[148:151], v[96:99]
    ds_write_b64 v13, v[88:89] offset:128
    v_cvt_pk_bf16_f32 v116, v116, v117
    v_mfma_f32_16x16x32_bf16 v[124:127], v[244:247], v[156:159], v[124:127]
    v_cvt_pk_bf16_f32 v117, v118, v119
    v_mfma_f32_16x16x32_bf16 v[124:127], v[240:243], v[152:155], v[124:127]
    ds_write_b64 v13, v[116:117] offset:3968
    s_nop 7
    v_cvt_pk_bf16_f32 v120, v120, v121
    v_cvt_pk_bf16_f32 v121, v122, v123
    ds_write_b64 v13, v[120:121] offset:4000
    v_cvt_pk_bf16_f32 v92, v92, v93
    v_cvt_pk_bf16_f32 v93, v94, v95
    ds_write_b64 v13, v[92:93] offset:160
    v_cvt_pk_bf16_f32 v96, v96, v97
    v_cvt_pk_bf16_f32 v97, v98, v99
    ds_write_b64 v13, v[96:97] offset:192
    v_cvt_pk_bf16_f32 v124, v124, v125
    v_cvt_pk_bf16_f32 v125, v126, v127
    ds_write_b64 v13, v[124:125] offset:4032
    ds_read_b128 v[160:163], v254 offset:192
    s_mov_b64 exec, s[54:55]
    ds_read_b128 v[128:131], v252 offset:0
    ds_read_b128 v[132:135], v252 offset:960
    ds_read_b128 v[136:139], v252 offset:1920
    ds_read_b128 v[140:143], v252 offset:2880
    ds_read_b128 v[144:147], v252 offset:3840
    ds_read_b128 v[148:151], v252 offset:4800
    ds_read_b128 v[152:155], v252 offset:5760
    ds_read_b128 v[156:159], v252 offset:6720
    s_mov_b64 exec, -1
    s_waitcnt lgkmcnt(8)
    buffer_store_dwordx4 v[160:163], v255, s[24:27], 0 offen
    s_mov_b64 exec, s[54:55]
    s_mov_b32 s40, 0
    s_waitcnt lgkmcnt(7)
    buffer_store_dwordx4 v[128:131], v253, s[24:27], s40 offen nt
    s_mov_b32 s40, 28672
    s_waitcnt lgkmcnt(6)
    buffer_store_dwordx4 v[132:135], v253, s[24:27], s40 offen nt
    s_mov_b32 s40, 57344
    s_waitcnt lgkmcnt(5)
    buffer_store_dwordx4 v[136:139], v253, s[24:27], s40 offen nt
    s_mov_b32 s40, 86016
    s_waitcnt lgkmcnt(4)
    buffer_store_dwordx4 v[140:143], v253, s[24:27], s40 offen nt
    s_mov_b32 s40, 114688
    s_waitcnt lgkmcnt(3)
    buffer_store_dwordx4 v[144:147], v253, s[24:27], s40 offen nt
    s_mov_b32 s40, 143360
    s_waitcnt lgkmcnt(2)
    buffer_store_dwordx4 v[148:151], v253, s[24:27], s40 offen nt
    s_mov_b32 s40, 172032
    s_waitcnt lgkmcnt(1)
    buffer_store_dwordx4 v[152:155], v253, s[24:27], s40 offen nt
    s_mov_b32 s40, 200704
    s_waitcnt lgkmcnt(0)
    buffer_store_dwordx4 v[156:159], v253, s[24:27], s40 offen nt
    s_endpgm
L_P:
    s_mov_b32 s16, s4
    s_and_b32 s17, s5, 0xffff
    s_mov_b32 s18, 4194304
    s_mov_b32 s19, 0x20000
    s_getpc_b64 s[98:99]
L_pc:
    s_sub_u32 s98, s98, 0x1a9c
    s_subb_u32 s99, s99, 0
    v_lshrrev_b32 v8, 3, v0
    v_lshrrev_b32 v9, 4, v0
    v_and_b32 v10, 7, v0
    v_xor_b32 v10, v10, v9
    v_xor_b32 v11, 4, v10
    s_lshl_b32 s40, s58, 6
    s_add_u32 s40, s40, s36
    s_lshl_b32 s40, s40, 11
    v_lshl_add_u32 v8, v8, 11, s40
    v_lshl_add_u32 v10, v10, 4, v8
    v_lshl_add_u32 v11, v11, 4, v8
    v_add_u32 v16, 0, v10
    v_add_u32 v17, 15360, v11
    v_add_u32 v18, 30720, v10
    v_add_u32 v19, 46080, v11
    v_add_u32 v20, 65536, v10
    v_add_u32 v21, 80896, v11
    v_add_u32 v22, 96256, v10
    v_add_u32 v23, 111616, v11
    s_lshl_b32 s48, s58, 13
    s_lshl_b32 s90, s37, 8
    s_add_u32 s90, s90, 128
    s_xor_b32 s91, s90, 128
    s_add_u32 s94, s90, 256
    s_and_b32 s94, s94, 2047
    s_add_u32 s95, s90, 512
    s_and_b32 s95, s95, 2047
    s_mov_b32 s78, 64
    s_mov_b64 s[52:53], 0
    s_lshl_b32 s73, s38, 6
    s_add_u32 s73, s73, 141312
    s_mul_i32 s89, s74, 14336
    s_add_u32 s89, s89, s59
    s_add_u32 s89, s89, s49
    s_lshl_b32 s88, s74, 2
    s_add_u32 s88, s88, s58
    s_lshl_b32 s88, s88, 3
    s_add_u32 s88, s88, s75
    s_getreg_b32 s79, hwreg(HW_REG_XCC_ID, 0, 4)
    s_add_u32 s41, s45, s49
    s_add_u32 s41, s41, 32768
    v_add_u32 v249, s41, v241
    s_mov_b32 s24, s12
    s_and_b32 s25, s13, 0xffff
    s_mov_b32 s26, 14680064
    s_mov_b32 s27, 0x20000
    v_lshrrev_b32 v3, 4, v0
    v_and_b32 v4, 15, v0
    s_mul_i32 s40, s58, 7680
    s_add_u32 s40, s40, 47104
    v_mul_u32_u24 v5, 240, v3
    v_lshl_add_u32 v5, v4, 4, v5
    v_add_u32 v28, s40, v5
    s_lshl_b32 s42, s58, 6
    s_add_u32 s42, s42, s36
    s_mul_i32 s42, s42, 7168
    s_add_u32 s42, s42, s43
    s_lshl_b32 s41, s33, 5
    s_add_u32 s41, s41, s42
    v_mul_u32_u24 v5, 7168, v3
    v_lshl_add_u32 v5, v4, 4, v5
    v_add_u32 v29, s41, v5
    s_cmp_eq_u32 s33, 1
    s_cselect_b32 s41, 0, 192
    s_add_u32 s42, s42, s41
    v_lshrrev_b32 v3, 1, v0
    v_and_b32 v4, 1, v0
    v_mul_u32_u24 v5, 7168, v3
    v_lshl_add_u32 v5, v4, 4, v5
    v_add_u32 v31, s42, v5
    v_mul_u32_u24 v5, 240, v3
    v_lshl_add_u32 v5, v4, 4, v5
    v_add_u32 v30, s40, v5
    s_mov_b32 s54, 0x0fff0fff
    s_mov_b32 s55, 0x0fff0fff
    buffer_load_dwordx2 v[24:25], v248, s[20:23], s75 offen sc1
    s_waitcnt vmcnt(7)
    v_lshlrev_b32 v6, 16, v6
    v_lshl_add_u32 v205, v0, 2, s73
    s_mov_b64 exec, 0xffff
    ds_write_b32 v205, v6
    s_mov_b64 exec, -1
    v_lshlrev_b32 v244, 16, v14
    v_and_b32 v245, 0xffff0000, v14
    v_lshlrev_b32 v246, 16, v15
    v_and_b32 v247, 0xffff0000, v15
    s_mov_b32 s40, 1664525
    s_mov_b32 s41, 22695477
    v_mul_lo_u32 v242, v242, s40
    v_mul_lo_u32 v243, v243, s41
    v_add_u32 v242, 1013904223, v242
    v_add_u32 v243, 0x3c6ef35f, v243
    v_and_b32 v242, -16, v242
    v_or_b32 v242, s79, v242
    s_mov_b64 exec, s[50:51]
    v_lshl_add_u32 v128, v128, 2, s73
    ds_read_b32 v128, v128
    v_lshl_add_u32 v129, v129, 2, s73
    ds_read_b32 v129, v129
    v_lshl_add_u32 v130, v130, 2, s73
    ds_read_b32 v130, v130
    v_lshl_add_u32 v131, v131, 2, s73
    ds_read_b32 v131, v131
    v_lshl_add_u32 v132, v132, 2, s73
    ds_read_b32 v132, v132
    v_lshl_add_u32 v133, v133, 2, s73
    ds_read_b32 v133, v133
    v_lshl_add_u32 v134, v134, 2, s73
    ds_read_b32 v134, v134
    v_lshl_add_u32 v135, v135, 2, s73
    ds_read_b32 v135, v135
    s_waitcnt lgkmcnt(4)
    v_pk_mul_f32 v[128:129], v[128:129], v[244:245]
    v_pk_mul_f32 v[130:131], v[130:131], v[246:247]
    v_cvt_pk_bf16_f32 v160, v128, v129
    v_cvt_pk_bf16_f32 v161, v130, v131
    s_waitcnt lgkmcnt(0)
    v_pk_mul_f32 v[132:133], v[132:133], v[244:245]
    v_pk_mul_f32 v[134:135], v[134:135], v[246:247]
    v_cvt_pk_bf16_f32 v162, v132, v133
    v_cvt_pk_bf16_f32 v163, v134, v135
    buffer_store_dwordx4 v[160:163], v241, s[20:23], s89 offen offset:0
    ds_write_b128 v249, v[160:163] offset:0
    s_mov_b64 exec, -1
    s_add_u32 m0, s48, 0
    s_nop 0
    buffer_load_dwordx4 v16, s[16:19], s90 offen lds
    buffer_load_dwordx4 v17, s[16:19], s90 offen offset:1024 lds
    buffer_load_dwordx4 v18, s[16:19], s90 offen offset:2048 lds
    buffer_load_dwordx4 v19, s[16:19], s90 offen offset:3072 lds
    s_mov_b64 exec, s[50:51]
    s_waitcnt vmcnt(10)
    v_lshl_add_u32 v136, v136, 2, s73
    ds_read_b32 v136, v136
    v_lshl_add_u32 v137, v137, 2, s73
    ds_read_b32 v137, v137
    v_lshl_add_u32 v138, v138, 2, s73
    ds_read_b32 v138, v138
    v_lshl_add_u32 v139, v139, 2, s73
    ds_read_b32 v139, v139
    v_lshl_add_u32 v140, v140, 2, s73
    ds_read_b32 v140, v140
    v_lshl_add_u32 v141, v141, 2, s73
    ds_read_b32 v141, v141
    v_lshl_add_u32 v142, v142, 2, s73
    ds_read_b32 v142, v142
    v_lshl_add_u32 v143, v143, 2, s73
    ds_read_b32 v143, v143
    s_waitcnt lgkmcnt(4)
    v_pk_mul_f32 v[136:137], v[136:137], v[244:245]
    v_pk_mul_f32 v[138:139], v[138:139], v[246:247]
    v_cvt_pk_bf16_f32 v164, v136, v137
    v_cvt_pk_bf16_f32 v165, v138, v139
    s_waitcnt lgkmcnt(0)
    v_pk_mul_f32 v[140:141], v[140:141], v[244:245]
    v_pk_mul_f32 v[142:143], v[142:143], v[246:247]
    v_cvt_pk_bf16_f32 v166, v140, v141
    v_cvt_pk_bf16_f32 v167, v142, v143
    buffer_store_dwordx4 v[164:167], v241, s[20:23], s89 offen offset:896
    ds_write_b128 v249, v[164:167] offset:896
    s_mov_b64 exec, -1
    s_add_u32 m0, s48, 4096
    s_nop 0
    buffer_load_dwordx4 v20, s[16:19], s90 offen lds
    buffer_load_dwordx4 v21, s[16:19], s90 offen offset:1024 lds
    buffer_load_dwordx4 v22, s[16:19], s90 offen offset:2048 lds
    buffer_load_dwordx4 v23, s[16:19], s90 offen offset:3072 lds
    s_mov_b64 exec, s[50:51]
    s_waitcnt vmcnt(13)
    v_lshl_add_u32 v144, v144, 2, s73
    ds_read_b32 v144, v144
    v_lshl_add_u32 v145, v145, 2, s73
    ds_read_b32 v145, v145
    v_lshl_add_u32 v146, v146, 2, s73
    ds_read_b32 v146, v146
    v_lshl_add_u32 v147, v147, 2, s73
    ds_read_b32 v147, v147
    v_lshl_add_u32 v148, v148, 2, s73
    ds_read_b32 v148, v148
    v_lshl_add_u32 v149, v149, 2, s73
    ds_read_b32 v149, v149
    v_lshl_add_u32 v150, v150, 2, s73
    ds_read_b32 v150, v150
    v_lshl_add_u32 v151, v151, 2, s73
    ds_read_b32 v151, v151
    s_waitcnt lgkmcnt(4)
    v_pk_mul_f32 v[144:145], v[144:145], v[244:245]
    v_pk_mul_f32 v[146:147], v[146:147], v[246:247]
    v_cvt_pk_bf16_f32 v168, v144, v145
    v_cvt_pk_bf16_f32 v169, v146, v147
    s_waitcnt lgkmcnt(0)
    v_pk_mul_f32 v[148:149], v[148:149], v[244:245]
    v_pk_mul_f32 v[150:151], v[150:151], v[246:247]
    v_cvt_pk_bf16_f32 v170, v148, v149
    v_cvt_pk_bf16_f32 v171, v150, v151
    buffer_store_dwordx4 v[168:171], v241, s[20:23], s89 offen offset:1792
    ds_write_b128 v249, v[168:171] offset:1792
    s_mov_b64 exec, -1
    s_add_u32 m0, s48, 47104
    s_nop 0
    buffer_load_dwordx4 v16, s[16:19], s91 offen lds
    buffer_load_dwordx4 v17, s[16:19], s91 offen offset:1024 lds
    buffer_load_dwordx4 v18, s[16:19], s91 offen offset:2048 lds
    buffer_load_dwordx4 v19, s[16:19], s91 offen offset:3072 lds
    s_mov_b64 exec, s[50:51]
    s_waitcnt vmcnt(16)
    v_lshl_add_u32 v152, v152, 2, s73
    ds_read_b32 v152, v152
    v_lshl_add_u32 v153, v153, 2, s73
    ds_read_b32 v153, v153
    v_lshl_add_u32 v154, v154, 2, s73
    ds_read_b32 v154, v154
    v_lshl_add_u32 v155, v155, 2, s73
    ds_read_b32 v155, v155
    v_lshl_add_u32 v156, v156, 2, s73
    ds_read_b32 v156, v156
    v_lshl_add_u32 v157, v157, 2, s73
    ds_read_b32 v157, v157
    v_lshl_add_u32 v158, v158, 2, s73
    ds_read_b32 v158, v158
    v_lshl_add_u32 v159, v159, 2, s73
    ds_read_b32 v159, v159
    s_waitcnt lgkmcnt(4)
    v_pk_mul_f32 v[152:153], v[152:153], v[244:245]
    v_pk_mul_f32 v[154:155], v[154:155], v[246:247]
    v_cvt_pk_bf16_f32 v172, v152, v153
    v_cvt_pk_bf16_f32 v173, v154, v155
    s_waitcnt lgkmcnt(0)
    v_pk_mul_f32 v[156:157], v[156:157], v[244:245]
    v_pk_mul_f32 v[158:159], v[158:159], v[246:247]
    v_cvt_pk_bf16_f32 v174, v156, v157
    v_cvt_pk_bf16_f32 v175, v158, v159
    buffer_store_dwordx4 v[172:175], v241, s[20:23], s89 offen offset:2688
    ds_write_b128 v249, v[172:175] offset:2688
    s_mov_b64 exec, -1
    s_add_u32 m0, s48, 51200
    s_nop 0
    buffer_load_dwordx4 v20, s[16:19], s91 offen lds
    buffer_load_dwordx4 v21, s[16:19], s91 offen offset:1024 lds
    buffer_load_dwordx4 v22, s[16:19], s91 offen offset:2048 lds
    buffer_load_dwordx4 v23, s[16:19], s91 offen offset:3072 lds
    s_waitcnt vmcnt(10)
    s_barrier
    s_add_u32 m0, s48, 94208
    s_nop 0
    buffer_load_dwordx4 v16, s[16:19], s94 offen lds
    buffer_load_dwordx4 v17, s[16:19], s94 offen offset:1024 lds
    buffer_load_dwordx4 v18, s[16:19], s94 offen offset:2048 lds
    buffer_load_dwordx4 v19, s[16:19], s94 offen offset:3072 lds
    s_add_u32 m0, s48, 98304
    s_nop 0
    buffer_load_dwordx4 v20, s[16:19], s94 offen lds
    buffer_load_dwordx4 v21, s[16:19], s94 offen offset:1024 lds
    buffer_load_dwordx4 v22, s[16:19], s94 offen offset:2048 lds
    buffer_load_dwordx4 v23, s[16:19], s94 offen offset:3072 lds
    buffer_load_dwordx2 v[24:25], v248, s[20:23], s75 offen sc1
    s_waitcnt vmcnt(9) lgkmcnt(0)
    s_barrier
    s_mov_b64 exec, 1
    buffer_store_dwordx2 v[242:243], v248, s[20:23], s88 offen
    s_mov_b64 exec, -1
    s_waitcnt vmcnt(1)
    v_cmp_eq_u64 s[52:53], v[24:25], v[242:243]
    s_nop 3
    s_lshr_b32 s74, s94, 7
    s_lshl_b32 s77, s74, 2
    s_add_u32 s77, s77, s58
    s_mul_i32 s47, s74, 14336
    s_add_u32 s47, s47, s59
    s_add_u32 s47, s47, s49
    s_mov_b32 s45, 94208
    s_bitcmp1_b64 s[52:53], s77
    s_cbranch_scc1 L_wok0
    s_mov_b32 s76, 0
L_wpoll0:
    buffer_load_dwordx2 v[24:25], v248, s[20:23], s75 offen sc1
    s_waitcnt vmcnt(0)
    v_cmp_eq_u64 s[52:53], v[24:25], v[242:243]
    s_nop 3
    s_add_u32 s76, s76, 1
    s_bitcmp1_b64 s[52:53], s77
    s_cbranch_scc1 L_wok0
    s_cmp_lt_u32 s76, s78
    s_cbranch_scc1 L_wpoll0
    s_call_b64 s[92:93], L_slow
    s_branch L_wdone0
L_wok0:
    s_add_u32 s41, s45, s49
    s_add_u32 m0, s41, 32768
    s_nop 0
    buffer_load_dwordx4 v241, s[20:23], s47 offen sc1 lds
    buffer_load_dwordx4 v241, s[20:23], s47 offen offset:1024 sc1 lds
    buffer_load_dwordx4 v241, s[20:23], s47 offen offset:2048 sc1 lds
    s_mov_b32 exec_hi, 0
    buffer_load_dwordx4 v241, s[20:23], s47 offen offset:3072 sc1 lds
    s_mov_b32 exec_hi, -1
L_wdone0:
    s_add_u32 m0, s48, 0
    s_nop 0
    buffer_load_dwordx4 v16, s[16:19], s95 offen lds
    buffer_load_dwordx4 v17, s[16:19], s95 offen offset:1024 lds
    buffer_load_dwordx4 v18, s[16:19], s95 offen offset:2048 lds
    buffer_load_dwordx4 v19, s[16:19], s95 offen offset:3072 lds
    s_add_u32 m0, s48, 4096
    s_nop 0
    buffer_load_dwordx4 v20, s[16:19], s95 offen lds
    buffer_load_dwordx4 v21, s[16:19], s95 offen offset:1024 lds
    buffer_load_dwordx4 v22, s[16:19], s95 offen offset:2048 lds
    buffer_load_dwordx4 v23, s[16:19], s95 offen offset:3072 lds
    s_lshr_b32 s74, s95, 7
    s_lshl_b32 s77, s74, 2
    s_add_u32 s77, s77, s58
    s_mul_i32 s47, s74, 14336
    s_add_u32 s47, s47, s59
    s_add_u32 s47, s47, s49
    s_mov_b32 s45, 0
    s_bitcmp1_b64 s[52:53], s77
    s_cbranch_scc1 L_wok1
    s_mov_b32 s76, 0
L_wpoll1:
    buffer_load_dwordx2 v[24:25], v248, s[20:23], s75 offen sc1
    s_waitcnt vmcnt(0)
    v_cmp_eq_u64 s[52:53], v[24:25], v[242:243]
    s_nop 3
    s_add_u32 s76, s76, 1
    s_bitcmp1_b64 s[52:53], s77
    s_cbranch_scc1 L_wok1
    s_cmp_lt_u32 s76, s78
    s_cbranch_scc1 L_wpoll1
    s_call_b64 s[92:93], L_slow
    s_branch L_wdone1
L_wok1:
    s_add_u32 s41, s45, s49
    s_add_u32 m0, s41, 32768
    s_nop 0
    buffer_load_dwordx4 v241, s[20:23], s47 offen sc1 lds
    buffer_load_dwordx4 v241, s[20:23], s47 offen offset:1024 sc1 lds
    buffer_load_dwordx4 v241, s[20:23], s47 offen offset:2048 sc1 lds
    s_mov_b32 exec_hi, 0
    buffer_load_dwordx4 v241, s[20:23], s47 offen offset:3072 sc1 lds
    s_mov_b32 exec_hi, -1
L_wdone1:
    s_waitcnt vmcnt(12)
    s_barrier
    s_cmp_eq_u32 s58, 0
    s_cselect_b32 s84, 7, 64
    s_lshr_b32 s85, s36, 5
    s_add_u32 s85, s85, s75
    s_add_u32 s85, s85, 512
    v_and_b32 v80, -16, v242
    v_mov_b32 v81, v243
    s_mov_b32 s56, 4
    s_mov_b32 s45, 47104
    s_add_u32 s46, s95, 256
    s_and_b32 s46, s46, 2047
    s_add_u32 s91, s59, s49
    s_movk_i32 s90, 256
    s_lshr_b32 s77, s46, 5
    s_add_u32 s77, s77, s58
    s_add_u32 m0, s45, s48
    s_setprio 2
L_P_loop:
    buffer_load_dwordx4 v16, s[16:19], s46 offen lds
    buffer_load_dwordx4 v17, s[16:19], s46 offen offset:1024 lds
    s_mul_i32 s47, s46, 112
    s_add_u32 s47, s47, s91
    buffer_load_dwordx4 v18, s[16:19], s46 offen offset:2048 lds
    s_sub_u32 s41, s56, s84
    s_cmp_gt_u32 s41, 2
    s_cbranch_scc1 L_P_noev
    s_cmp_eq_u32 s41, 1
    s_cbranch_scc1 L_P_noev
    s_cmp_eq_u32 s41, 2
    s_cbranch_scc1 L_P_ev2
    s_mov_b64 exec, 1
    buffer_store_dwordx2 v[80:81], v248, s[20:23], s85 offen sc1
    s_branch L_P_ev3
L_P_ev2:
    s_mov_b64 exec, 0xff
    buffer_load_dwordx2 v[82:83], v248, s[20:23], s75 offen offset:512 sc1
L_P_ev3:
    s_mov_b64 exec, -1
L_P_noev:
    buffer_load_dwordx4 v19, s[16:19], s46 offen offset:3072 lds
    s_add_u32 m0, m0, 4096
    s_lshr_b32 s74, s46, 7
    buffer_load_dwordx4 v20, s[16:19], s46 offen lds
    s_add_u32 s42, s45, s49
    s_add_u32 s42, s42, 32768
    buffer_load_dwordx4 v21, s[16:19], s46 offen offset:1024 lds
    s_lshl_b32 s96, s56, 2
    s_add_u32 s96, s96, s58
    s_lshl_b32 s96, s96, 6
    s_add_u32 s96, s96, 0x1080 - 1024
    s_load_dword s97, s[98:99], s96
    buffer_load_dwordx4 v22, s[16:19], s46 offen offset:2048 lds
    buffer_load_dwordx4 v23, s[16:19], s46 offen offset:3072 lds
    s_bitcmp1_b64 s[52:53], s77
    s_cbranch_scc1 L_P_w
    s_mov_b32 s76, 0
L_P_poll:
    buffer_load_dwordx2 v[24:25], v248, s[20:23], s75 offen sc1
    s_waitcnt vmcnt(0)
    v_cmp_eq_u64 s[52:53], v[24:25], v[242:243]
    s_nop 3
    s_add_u32 s76, s76, 1
    s_bitcmp1_b64 s[52:53], s77
    s_cbranch_scc1 L_P_w
    s_cmp_lt_u32 s76, s78
    s_cbranch_scc1 L_P_poll
    s_call_b64 s[92:93], L_slow
    s_mov_b32 s42, 141824
    s_mov_b32 s47, 0x7ff00000
L_P_w:
    s_mov_b32 m0, s42
    s_cmp_eq_u32 s56, 8
    buffer_load_dwordx4 v241, s[20:23], s47 offen sc1 lds
    s_cselect_b32 s40, 384, s90
    s_add_u32 s46, s46, s40
    s_and_b32 s46, s46, 2047
    s_lshr_b32 s77, s46, 5
    s_add_u32 s77, s77, s58
    buffer_load_dwordx4 v241, s[20:23], s47 offen offset:1024 sc1 lds
    s_add_u32 s45, s45, 47104
    s_cmp_eq_u32 s45, 141312
    s_cselect_b32 s45, 0, s45
    buffer_load_dwordx4 v241, s[20:23], s47 offen offset:2048 sc1 lds
    s_add_u32 s56, s56, 1
    s_add_u32 s40, s45, s48
    s_mov_b32 exec_hi, 0
    buffer_load_dwordx4 v241, s[20:23], s47 offen offset:3072 sc1 lds
    s_mov_b32 exec_hi, -1
    s_mov_b32 m0, s40
    s_cmp_eq_u64 s[52:53], -1
    s_waitcnt vmcnt(12)
    s_cbranch_scc1 L_P_nopoll
    v_cmp_eq_u64 s[52:53], v[24:25], v[242:243]
    buffer_load_dwordx2 v[24:25], v248, s[20:23], s75 offen sc1
L_P_nopoll:
    s_cmp_lt_u32 s56, 16
    s_barrier
    s_cbranch_scc1 L_P_loop
L_P_tail:
    s_waitcnt vmcnt(0)
    s_barrier
    s_waitcnt lgkmcnt(0)
    s_cmp_lg_u32 s58, 0
    s_cbranch_scc1 L_P_e
    s_mov_b64 exec, 0xff
    v_cmp_eq_u64 vcc, v[82:83], v[80:81]
    s_nop 3
    s_cmp_lg_u32 vcc_lo, 0xff
    s_cbranch_scc1 L_P_e2
    s_mov_b64 exec, 1
    buffer_store_dwordx2 v[80:81], v248, s[20:23], s75 offen offset:640 sc1
L_P_e2:
    s_mov_b64 exec, -1
L_P_e:
    s_barrier
    ds_read_b128 v[64:67], v30 offset:192
    s_mov_b64 exec, s[54:55]
    ds_read_b128 v[32:35], v28 offset:0
    ds_read_b128 v[36:39], v28 offset:960
    ds_read_b128 v[40:43], v28 offset:1920
    ds_read_b128 v[44:47], v28 offset:2880
    ds_read_b128 v[48:51], v28 offset:3840
    ds_read_b128 v[52:55], v28 offset:4800
    ds_read_b128 v[56:59], v28 offset:5760
    ds_read_b128 v[60:63], v28 offset:6720
    s_mov_b64 exec, -1
    s_waitcnt lgkmcnt(8)
    buffer_store_dwordx4 v[64:67], v31, s[24:27], 0 offen
    s_mov_b64 exec, s[54:55]
    s_mov_b32 s40, 0
    s_waitcnt lgkmcnt(7)
    buffer_store_dwordx4 v[32:35], v29, s[24:27], s40 offen nt
    s_mov_b32 s40, 28672
    s_waitcnt lgkmcnt(6)
    buffer_store_dwordx4 v[36:39], v29, s[24:27], s40 offen nt
    s_mov_b32 s40, 57344
    s_waitcnt lgkmcnt(5)
    buffer_store_dwordx4 v[40:43], v29, s[24:27], s40 offen nt
    s_mov_b32 s40, 86016
    s_waitcnt lgkmcnt(4)
    buffer_store_dwordx4 v[44:47], v29, s[24:27], s40 offen nt
    s_mov_b32 s40, 114688
    s_waitcnt lgkmcnt(3)
    buffer_store_dwordx4 v[48:51], v29, s[24:27], s40 offen nt
    s_mov_b32 s40, 143360
    s_waitcnt lgkmcnt(2)
    buffer_store_dwordx4 v[52:55], v29, s[24:27], s40 offen nt
    s_mov_b32 s40, 172032
    s_waitcnt lgkmcnt(1)
    buffer_store_dwordx4 v[56:59], v29, s[24:27], s40 offen nt
    s_mov_b32 s40, 200704
    s_waitcnt lgkmcnt(0)
    buffer_store_dwordx4 v[60:63], v29, s[24:27], s40 offen nt
L_P_fin:
L_end:
    s_endpgm
L_slow:
    s_waitcnt lgkmcnt(0)
    s_mov_b32 s78, 0
    s_lshl_b32 s72, s74, 2
    s_add_u32 s72, s72, s58
    s_mul_i32 s72, s72, 229376
    s_mul_i32 s40, s39, 448
    s_add_u32 s72, s72, s40
    s_add_u32 s41, s45, s49
    s_add_u32 s41, s41, 32768
    v_add_u32 v249, s41, v241
    s_mov_b64 exec, s[50:51]
    buffer_load_dwordx4 v[32:35], v240, s[28:31], s72 offen nt
    s_add_u32 s40, s72, 14336
    buffer_load_dwordx4 v[36:39], v240, s[28:31], s40 offen nt
    s_add_u32 s40, s72, 114688
    buffer_load_dwordx4 v[40:43], v240, s[28:31], s40 offen nt
    s_add_u32 s40, s72, 129024
    buffer_load_dwordx4 v[44:47], v240, s[28:31], s40 offen nt
    s_add_u32 s40, s72, 57344
    buffer_load_dwordx4 v[48:51], v240, s[28:31], s40 offen nt
    s_add_u32 s40, s72, 71680
    buffer_load_dwordx4 v[52:55], v240, s[28:31], s40 offen nt
    s_add_u32 s40, s72, 172032
    buffer_load_dwordx4 v[56:59], v240, s[28:31], s40 offen nt
    s_add_u32 s40, s72, 186368
    buffer_load_dwordx4 v[60:63], v240, s[28:31], s40 offen nt
    s_waitcnt vmcnt(6)
    v_lshl_add_u32 v32, v32, 2, s73
    ds_read_b32 v32, v32
    v_lshl_add_u32 v33, v33, 2, s73
    ds_read_b32 v33, v33
    v_lshl_add_u32 v34, v34, 2, s73
    ds_read_b32 v34, v34
    v_lshl_add_u32 v35, v35, 2, s73
    ds_read_b32 v35, v35
    v_lshl_add_u32 v36, v36, 2, s73
    ds_read_b32 v36, v36
    v_lshl_add_u32 v37, v37, 2, s73
    ds_read_b32 v37, v37
    v_lshl_add_u32 v38, v38, 2, s73
    ds_read_b32 v38, v38
    v_lshl_add_u32 v39, v39, 2, s73
    ds_read_b32 v39, v39
    s_waitcnt lgkmcnt(4)
    v_pk_mul_f32 v[32:33], v[32:33], v[244:245]
    v_pk_mul_f32 v[34:35], v[34:35], v[246:247]
    v_cvt_pk_bf16_f32 v64, v32, v33
    v_cvt_pk_bf16_f32 v65, v34, v35
    s_waitcnt lgkmcnt(0)
    v_pk_mul_f32 v[36:37], v[36:37], v[244:245]
    v_pk_mul_f32 v[38:39], v[38:39], v[246:247]
    v_cvt_pk_bf16_f32 v66, v36, v37
    v_cvt_pk_bf16_f32 v67, v38, v39
    ds_write_b128 v249, v[64:67] offset:0
    s_waitcnt vmcnt(4)
    v_lshl_add_u32 v40, v40, 2, s73
    ds_read_b32 v40, v40
    v_lshl_add_u32 v41, v41, 2, s73
    ds_read_b32 v41, v41
    v_lshl_add_u32 v42, v42, 2, s73
    ds_read_b32 v42, v42
    v_lshl_add_u32 v43, v43, 2, s73
    ds_read_b32 v43, v43
    v_lshl_add_u32 v44, v44, 2, s73
    ds_read_b32 v44, v44
    v_lshl_add_u32 v45, v45, 2, s73
    ds_read_b32 v45, v45
    v_lshl_add_u32 v46, v46, 2, s73
    ds_read_b32 v46, v46
    v_lshl_add_u32 v47, v47, 2, s73
    ds_read_b32 v47, v47
    s_waitcnt lgkmcnt(4)
    v_pk_mul_f32 v[40:41], v[40:41], v[244:245]
    v_pk_mul_f32 v[42:43], v[42:43], v[246:247]
    v_cvt_pk_bf16_f32 v68, v40, v41
    v_cvt_pk_bf16_f32 v69, v42, v43
    s_waitcnt lgkmcnt(0)
    v_pk_mul_f32 v[44:45], v[44:45], v[244:245]
    v_pk_mul_f32 v[46:47], v[46:47], v[246:247]
    v_cvt_pk_bf16_f32 v70, v44, v45
    v_cvt_pk_bf16_f32 v71, v46, v47
    ds_write_b128 v249, v[68:71] offset:896
    s_waitcnt vmcnt(2)
    v_lshl_add_u32 v48, v48, 2, s73
    ds_read_b32 v48, v48
    v_lshl_add_u32 v49, v49, 2, s73
    ds_read_b32 v49, v49
    v_lshl_add_u32 v50, v50, 2, s73
    ds_read_b32 v50, v50
    v_lshl_add_u32 v51, v51, 2, s73
    ds_read_b32 v51, v51
    v_lshl_add_u32 v52, v52, 2, s73
    ds_read_b32 v52, v52
    v_lshl_add_u32 v53, v53, 2, s73
    ds_read_b32 v53, v53
    v_lshl_add_u32 v54, v54, 2, s73
    ds_read_b32 v54, v54
    v_lshl_add_u32 v55, v55, 2, s73
    ds_read_b32 v55, v55
    s_waitcnt lgkmcnt(4)
    v_pk_mul_f32 v[48:49], v[48:49], v[244:245]
    v_pk_mul_f32 v[50:51], v[50:51], v[246:247]
    v_cvt_pk_bf16_f32 v72, v48, v49
    v_cvt_pk_bf16_f32 v73, v50, v51
    s_waitcnt lgkmcnt(0)
    v_pk_mul_f32 v[52:53], v[52:53], v[244:245]
    v_pk_mul_f32 v[54:55], v[54:55], v[246:247]
    v_cvt_pk_bf16_f32 v74, v52, v53
    v_cvt_pk_bf16_f32 v75, v54, v55
    ds_write_b128 v249, v[72:75] offset:1792
    s_waitcnt vmcnt(0)
    v_lshl_add_u32 v56, v56, 2, s73
    ds_read_b32 v56, v56
    v_lshl_add_u32 v57, v57, 2, s73
    ds_read_b32 v57, v57
    v_lshl_add_u32 v58, v58, 2, s73
    ds_read_b32 v58, v58
    v_lshl_add_u32 v59, v59, 2, s73
    ds_read_b32 v59, v59
    v_lshl_add_u32 v60, v60, 2, s73
    ds_read_b32 v60, v60
    v_lshl_add_u32 v61, v61, 2, s73
    ds_read_b32 v61, v61
    v_lshl_add_u32 v62, v62, 2, s73
    ds_read_b32 v62, v62
    v_lshl_add_u32 v63, v63, 2, s73
    ds_read_b32 v63, v63
    s_waitcnt lgkmcnt(4)
    v_pk_mul_f32 v[56:57], v[56:57], v[244:245]
    v_pk_mul_f32 v[58:59], v[58:59], v[246:247]
    v_cvt_pk_bf16_f32 v76, v56, v57
    v_cvt_pk_bf16_f32 v77, v58, v59
    s_waitcnt lgkmcnt(0)
    v_pk_mul_f32 v[60:61], v[60:61], v[244:245]
    v_pk_mul_f32 v[62:63], v[62:63], v[246:247]
    v_cvt_pk_bf16_f32 v78, v60, v61
    v_cvt_pk_bf16_f32 v79, v62, v63
    ds_write_b128 v249, v[76:79] offset:2688
    s_mov_b64 exec, -1
    s_waitcnt vmcnt(0) lgkmcnt(0)
    s_setpc_b64 s[92:93]
.section .rodata,"a"
.p2align 6
.amdhsa_kernel standalone__normalfloat_lut_codebook_lookup__prompt_kernel
  .amdhsa_next_free_vgpr 256
  .amdhsa_next_free_sgpr 102
  .amdhsa_accum_offset 256
  .amdhsa_group_segment_fixed_size 0
  .amdhsa_kernarg_size 56
  .amdhsa_user_sgpr_count 2
  .amdhsa_user_sgpr_kernarg_segment_ptr 1
  .amdhsa_system_sgpr_workgroup_id_x 1
  .amdhsa_float_denorm_mode_32 3
.end_amdhsa_kernel
```
